```python
import torch

def _softmax(x, axis=-1):
    return torch.softmax(x, dim=axis)
def _gelu(x):
    return torch.nn.functional.gelu(x, approximate="tanh")
def _silu(x):
    return torch.nn.functional.silu(x)
def _sigmoid(x):
    return torch.sigmoid(x)
def _layernorm(x, axis=-1, eps=1e-5):
    m = x.mean(dim=axis, keepdim=True)
    v = x.var(dim=axis, keepdim=True, unbiased=False)
    return (x - m) / torch.sqrt(v + eps)
def _scatter_add(tgt, idx, src, axis=0):
    return tgt.clone().index_add_(axis, idx, src)
def _segment_sum(src, seg, n):
    out = torch.zeros((n,) + src.shape[1:], dtype=src.dtype)
    return out.index_add_(0, seg, src)
def _pad(x, pw):
    flat = tuple(v for pair in reversed(pw) for v in pair)
    return torch.nn.functional.pad(x, flat)

kernel_name = 'interleave_layers__sliding_local_dilated__moe_arch_mod__prompt'

def setup_inputs():

    _w = (lambda a: (lambda t: t.to(torch.bfloat16) if t.is_floating_point() else t)(torch.as_tensor(a)))
    def _A_setup():
        B, S, D = 1, 2048, 512
        return {
            "x": _w((lambda *s: torch.randn(*s, dtype=torch.bfloat16) * 0.05)(B, S, D)),
            "wqkv": _w((lambda *s: torch.randn(*s, dtype=torch.bfloat16) * 0.05)(D, 3 * D)),
            "wo": _w((lambda *s: torch.randn(*s, dtype=torch.bfloat16) * 0.05)(D, D)),
        }
    _A_in = _A_setup()

    def _B_setup():
        B, S, D, F, C = 1, 2048, 512, 1376, 1
        return {
            "x": _w((lambda *s: torch.randn(*s, dtype=torch.bfloat16) * 0.05)(B, S, D)),
            "w_r": _w((lambda *s: torch.randn(*s, dtype=torch.bfloat16) * 0.05)(D)),
            "w_gate": _w((lambda *s: torch.randn(*s, dtype=torch.bfloat16) * 0.05)(D, F)),
            "w_up": _w((lambda *s: torch.randn(*s, dtype=torch.bfloat16) * 0.05)(D, F)),
            "w_down": _w((lambda *s: torch.randn(*s, dtype=torch.bfloat16) * 0.05)(F, D)),
        }
    _B_in = _B_setup()

    return {
        "A_x": _A_in["x"],
        "A_wqkv": _A_in["wqkv"],
        "A_wo": _A_in["wo"],
        "B_x": _B_in["x"],
        "B_w_r": _B_in["w_r"],
        "B_w_gate": _B_in["w_gate"],
        "B_w_up": _B_in["w_up"],
        "B_w_down": _B_in["w_down"],
    }

def reference(A_x, A_wqkv, A_wo, B_x, B_w_r, B_w_gate, B_w_up, B_w_down):
    def _A_ref(x, wqkv, wo):
        B, S, D = x.shape
        H = 32; Dh = D // H
        W, dil = 8, 2
        qkv = (lambda x, *d: x.permute(*d))((x @ wqkv).reshape(B, S, 3, H, Dh), 2, 0, 3, 1, 4)
        q, k, v = qkv[0], qkv[1], qkv[2]
        scale = Dh ** -0.5
        pos = torch.arange(S)
        off = torch.arange(W) * dil
        idx = pos[:, None] - off[None, :]
        mask = idx >= 0
        idx_c = torch.where(mask, idx, 0).reshape(-1)
        kg = k[:, :, idx_c, :].reshape(B, H, S, W, Dh)
        vg = v[:, :, idx_c, :].reshape(B, H, S, W, Dh)
        logits = torch.einsum("bhsd,bhswd->bhsw", q, kg) * scale
        logits = torch.where(mask[None, None, :, :], logits, -1e9)
        attn = _softmax(logits, axis=-1)
        o = torch.einsum("bhsw,bhswd->bhsd", attn, vg)
        return (lambda x, *d: x.permute(*d))(o, 0, 2, 1, 3).reshape(B, S, D) @ wo

    def _B_ref(x, w_r, w_gate, w_up, w_down):
        B, S, D = x.shape
        C = 1
        r = x @ w_r
        idx = torch.argsort(-r, axis=-1)[:, :C]
        idx_e = (lambda x, n, axis: torch.repeat_interleave(x, n, dim=axis))(idx.reshape(B, C, 1), D, axis=2)
        x_sel = (lambda x, i, axis: torch.take_along_dim(x, i, dim=axis))(x, idx_e, axis=1)
        g = _silu(x_sel @ w_gate)
        u = x_sel @ w_up
        y = (g * u) @ w_down
        r_sel = _sigmoid((lambda x, i, axis: torch.take_along_dim(x, i, dim=axis))(r, idx, axis=1))
        y = y * r_sel.reshape(B, C, 1)
        b_off = (torch.arange(B) * S).reshape(B, 1)
        flat_idx = (idx + b_off).reshape(B * C)
        zero = (x * 0.0).reshape(B * S, D)
        upd = _scatter_add(zero, flat_idx, y.reshape(B * C, D), axis=0)
        return x + upd.reshape(B, S, D)

    x = A_x
    x = x + _A_ref(_layernorm(x, axis=-1), A_wqkv, A_wo)
    x = x + _B_ref(_layernorm(x, axis=-1), B_w_r, B_w_gate, B_w_up, B_w_down)
    x = x + _A_ref(_layernorm(x, axis=-1), A_wqkv, A_wo)
    x = x + _B_ref(_layernorm(x, axis=-1), B_w_r, B_w_gate, B_w_up, B_w_down)
    return x
```

```asm
; @launch grid=(256,1,1) block=(256,1,1) lds=163840
.amdgcn_target "amdgcn-amd-amdhsa--gfx950"
.text
.globl interleave_layers__sliding_local_dilated__moe_arch_mod__prompt_kernel
.p2align 8
.type interleave_layers__sliding_local_dilated__moe_arch_mod__prompt_kernel,@function
interleave_layers__sliding_local_dilated__moe_arch_mod__prompt_kernel:
    s_load_dwordx2 s[8:9], s[0:1], 0
    s_load_dwordx2 s[12:13], s[0:1], 8
    s_load_dwordx2 s[16:17], s[0:1], 16
    s_load_dwordx2 s[20:21], s[0:1], 80
    s_load_dwordx2 s[42:43], s[0:1], 32
    s_cmp_ge_u32 s2, 256
    s_cbranch_scc1 L_end
    s_getpc_b64 s[40:41]
    v_lshrrev_b32 v134, 5, v0
    v_and_b32 v0, 63, v0
    s_lshr_b32 s58, s2, 3
    v_readfirstlane_b32 s3, v134
    s_lshl_b32 s10, s58, 10
    v_lshl_add_u32 v136, v134, 7, s10
    s_mov_b32 exec_lo, 1
    s_mov_b32 exec_hi, 1
    global_load_dword v17, v136, s[40:41]
    s_mov_b64 exec, -1
    s_lshr_b32 s3, s3, 1
    s_and_b32 s4, s58, 7
    s_and_b32 s5, s2, 7
    s_lshl_b32 s5, s5, 2
    s_lshr_b32 s10, s2, 6
    s_add_u32 s5, s5, s10
    v_lshrrev_b32 v2, 4, v0
    v_lshrrev_b32 v134, 3, v0
    v_and_b32 v135, 7, v0
    s_and_b32 s10, s3, 1
    s_lshl_b32 s10, s10, 2
    v_xor_b32 v136, v135, v2
    v_xor_b32 v136, s10, v136
    v_lshlrev_b32 v136, 4, v136
    v_lshl_add_u32 v73, v134, 11, v136
    v_lshl_add_u32 v72, s4, 7, v73
    s_lshl_b32 s66, s3, 10
    s_and_b32 s10, s5, 15
    s_lshl_b32 s10, s10, 3
    s_add_u32 s10, s10, s3
    s_lshl_b32 s10, s10, 14
    s_lshr_b32 s11, s5, 4
    s_lshl_b32 s11, s11, 10
    s_add_u32 s64, s10, s11
    s_sub_u32 s61, s64, 32768
    s_cselect_b32 s61, s64, s61
    s_add_u32 s62, s64, 32768
    s_cmp_eq_u32 s3, 0
    s_cselect_b32 s6, 0xffffff00, -1
    s_mov_b32 s10, 0x200000
    s_mov_b32 s11, 0x20000
    s_waitcnt lgkmcnt(0)
    s_add_u32 m0, s66, 0
    s_mov_b32 exec_lo, s6
    buffer_load_dwordx4 v72, s[8:11], s61 offen lds
    s_mov_b32 exec_lo, -1
    s_add_u32 m0, s66, 4096
    s_nop 0
    buffer_load_dwordx4 v72, s[8:11], s62 offen lds
    s_mov_b32 s14, 0x76543210
    s_mov_b32 s15, 0x76543210
    s_bitcmp1_b32 s5, 0
    s_cselect_b32 s14, 0x76543210, s14
    s_cselect_b32 s15, 0x76543210, s15
    s_bitcmp1_b32 s5, 1
    s_cselect_b32 s14, s15, s14
    s_mul_i32 s15, s4, 0x11111111
    s_add_u32 s14, s14, s15
    s_and_b32 s96, s14, 0x77777777
    s_add_u32 s65, s64, 65536
    s_sub_u32 s14, s64, 65536
    s_cselect_b32 s14, s64, s14
    s_add_u32 s15, s64, 98304
    s_lshr_b32 s97, s96, 4
    s_cmp_lt_u32 s3, 2
    s_cselect_b32 s63, s15, s14
    s_cselect_b32 s97, s96, s97
    s_cmp_eq_u32 s3, 2
    s_cselect_b32 s54, 0xffffff00, -1
    s_bfe_u32 s59, s97, 0x30000
    s_add_u32 m0, s66, 8192
    v_lshl_add_u32 v72, s59, 7, v73
    s_mov_b32 exec_lo, s54
    buffer_load_dwordx4 v72, s[8:11], s63 offen lds
    s_mov_b32 exec_lo, -1
    s_load_dwordx2 s[24:25], s[0:1], 40
    s_load_dwordx2 s[28:29], s[0:1], 48
    s_load_dwordx2 s[32:33], s[0:1], 56
    s_load_dwordx2 s[36:37], s[0:1], 64
    s_load_dwordx2 s[40:41], s[0:1], 72
    v_and_b32 v1, 15, v0
    s_movk_i32 s14, 3072
    s_cmp_eq_u32 s3, 3
    s_cselect_b32 s14, 1024, s14
    s_cselect_b32 s15, 0, s66
    s_cselect_b64 s[70:71], s[16:17], s[12:13]
    v_lshl_add_u32 v136, s5, 4, v1
    v_mul_u32_u24 v136, s14, v136
    s_lshl_b32 s18, s4, 7
    s_add_u32 s18, s18, s15
    v_add_u32 v136, s18, v136
    s_mov_b64 exec, 0xffff
    global_load_dword v17, v136, s[70:71]
    s_mov_b64 exec, -1
    v_lshlrev_b32 v3, 4, v0
    global_load_dwordx4 v[124:127], v3, s[42:43]
    v_lshl_add_u32 v136, s58, 4, v1
    v_mul_u32_u24 v136, s14, v136
    s_add_u32 s15, s15, 384
    v_add_u32 v253, s15, v136
    s_bfe_u32 s59, s96, 0x30004
    s_add_u32 m0, s66, 12288
    v_lshl_add_u32 v72, s59, 7, v73
    buffer_load_dwordx4 v72, s[8:11], s64 offen lds
    s_add_u32 m0, s66, 16384
    s_nop 0
    buffer_load_dwordx4 v72, s[8:11], s65 offen lds
    s_mov_b32 s14, 1572864
    s_mov_b32 s15, 0x20000
    s_mov_b32 s18, 524288
    s_mov_b32 s19, 0x20000
    s_mov_b32 s22, 8388608
    s_mov_b32 s23, 0x20000
    s_mov_b32 s26, 1409024
    s_mov_b32 s27, 0x20000
    s_mov_b32 s30, 1409024
    s_mov_b32 s31, 0x20000
    s_mov_b32 s34, 1409024
    s_mov_b32 s35, 0x20000
    s_mov_b32 s38, 2097152
    s_mov_b32 s39, 0x20000
    s_lshl_b32 s0, s4, 7
    v_lshl_add_u32 v92, v2, 4, s0
    v_and_b32 v136, 1, v2
    v_lshlrev_b32 v136, 1, v136
    v_xor_b32 v136, v135, v136
    v_lshl_add_u32 v136, v136, 4, s0
    s_lshl_b32 s1, s3, 4
    v_add_u32 v137, s1, v134
    v_mul_u32_u24 v138, 3072, v137
    v_add_u32 v75, v138, v136
    v_xor_b32 v139, 64, v136
    v_add_u32 v138, 24576, v138
    v_add_u32 v76, v138, v139
    v_lshl_add_u32 v77, v137, 10, v136
    v_lshl_add_u32 v78, v137, 10, v139
    v_add_u32 v78, 7168, v78
    s_mul_i32 s67, s3, 6144
    s_add_u32 s67, s67, 81920
    s_lshl_b32 s60, s3, 11
    s_bfe_u32 s68, s96, 0x30000
    s_mul_i32 s68, s68, 196608
    s_add_u32 m0, s67, 0
    s_nop 0
    buffer_load_dwordx4 v75, s[12:15], s68 offen offset:0 lds
    buffer_load_dwordx4 v75, s[12:15], s68 offen offset:1024 lds
    v_mov_b32 v46, 0x3f803f80
    v_mov_b32 v47, 0x3f803f80
    v_mov_b32 v48, 0x3f803f80
    v_mov_b32 v49, 0x3f803f80
    v_add_u32 v4, 65536, v3
    v_add_u32 v5, 147456, v3
    v_lshrrev_b32 v136, 1, v1
    v_xor_b32 v137, v2, v136
    v_lshlrev_b32 v137, 4, v137
    v_lshl_add_u32 v79, v1, 7, v137
    v_xor_b32 v80, 64, v79
    v_add_u32 v81, 40960, v79
    v_add_u32 v82, 40960, v80
    s_add_u32 s1, s60, 2048
    v_add_u32 v85, s1, v79
    v_add_u32 v86, s1, v80
    v_add_u32 v87, s1, v81
    v_add_u32 v88, s1, v82
    v_lshrrev_b32 v137, 1, v2
    s_lshl_b32 s0, s3, 1
    v_add_u32 v137, s0, v137
    v_xor_b32 v137, v137, v136
    v_lshlrev_b32 v137, 4, v137
    v_lshl_add_u32 v137, v1, 7, v137
    v_and_b32 v138, 1, v2
    v_lshl_add_u32 v93, v138, 3, v137
    v_mul_u32_u24 v137, 10240, v134
    v_lshl_add_u32 v94, v135, 4, v137
    ds_write_b128 v94, v[46:49]
    v_lshrrev_b32 v136, 2, v1
    v_lshrrev_b32 v137, 3, v1
    v_lshl_or_b32 v137, v138, 1, v137
    v_xor_b32 v137, s3, v137
    v_lshlrev_b32 v137, 5, v137
    v_lshl_add_u32 v137, v136, 7, v137
    v_and_b32 v138, 3, v0
    v_lshl_add_u32 v137, v138, 3, v137
    v_mul_u32_u24 v139, 3072, v2
    v_add_u32 v139, 81920, v139
    v_add_u32 v83, v139, v137
    v_lshl_add_u32 v84, v2, 10, v137
    v_cmp_eq_u32 s[44:45], v136, v2
    v_and_b32 v137, 1, v0
    v_cmp_eq_u32 s[46:47], 1, v137
    v_and_b32 v137, 2, v0
    v_cmp_eq_u32 s[48:49], 2, v137
    s_lshr_b32 s0, s5, 2
    s_min_u32 s1, s0, 3
    s_mul_i32 s7, s0, 5
    s_add_u32 s1, s1, s7
    s_cmp_lt_u32 s0, 3
    s_cselect_b32 s0, 6, 5
    s_and_b32 s7, s5, 3
    s_and_b32 s57, s4, 4
    s_add_u32 s7, s7, s57
    s_cmp_lt_u32 s7, s0
    s_cselect_b32 s0, 1, 7
    s_add_u32 s7, s7, s1
    s_and_b32 s57, s4, 3
    s_cmp_eq_u32 s57, s0
    s_cselect_b32 s7, s7, -1
    s_mul_i32 s100, s5, 24576
    s_add_u32 s100, s100, 5308416
    s_mul_i32 s101, s5, 2304
    s_add_u32 s101, s101, 6094848
    s_getreg_b32 s53, hwreg(HW_REG_XCC_ID)
    s_and_b32 s53, s53, 15
    s_waitcnt lgkmcnt(0)
    s_lshl2_add_u32 s0, s58, s3
    s_lshl_b32 s57, s0, 2
    v_add_u32 v137, s57, v136
    v_mul_u32_u24 v137, 2752, v137
    s_lshl_b32 s57, s1, 6
    v_lshl_add_u32 v139, v138, 7, s57
    v_add_u32 v137, v137, v139
    s_mul_i32 s0, s0, 1536
    s_lshl_b32 s57, s1, 15
    s_add_u32 s0, s0, s57
    v_lshl_add_u32 v139, v1, 7, s0
    v_mov_b32 v70, s24
    v_mov_b32 v71, s25
    s_mov_b32 exec_lo, 0xffff0000
    v_mov_b32 v70, s28
    v_mov_b32 v71, s29
    s_mov_b32 exec_lo, 0
    v_mov_b32 v70, s32
    v_mov_b32 v71, s33
    v_mov_b32 v137, v139
    s_mov_b32 exec_hi, 0xffff0000
    v_mov_b32 v70, s42
    v_mov_b32 v71, s43
    v_mov_b32 v137, 0
    s_mov_b64 exec, -1
    v_min_u32 v137, 1409020, v137
    v_add_co_u32 v70, vcc, v70, v137
    s_nop 1
    v_addc_co_u32 v71, vcc, 0, v71, vcc
    v_lshrrev_b32 v137, 2, v0
    s_lshl_b32 s0, s3, 7
    v_add_u32 v137, s0, v137
    v_mul_u32_u24 v137, 2752, v137
    v_and_b32 v139, 2, v2
    v_xor_b32 v139, v138, v139
    v_lshl_add_u32 v96, v139, 4, v137
    s_cmp_lt_i32 s7, 0
    s_cselect_b32 s26, 0, s26
    s_cselect_b32 s30, 0, s30
    s_cselect_b32 s34, 0, s34
    s_mul_i32 s0, s5, 81920
    s_lshl_b32 s1, s4, 11
    s_lshl_b32 s57, s3, 9
    s_add_u32 s57, s57, s1
    s_add_u32 s57, s57, s0
    v_lshrrev_b32 v137, 2, v0
    v_lshlrev_b32 v137, 14, v137
    v_lshl_add_u32 v137, v138, 7, v137
    v_add_u32 v90, s57, v137
    v_lshrrev_b32 v136, 1, v2
    v_lshlrev_b32 v136, 8, v136
    v_lshl_add_u32 v136, v1, 4, v136
    v_and_b32 v137, 1, v2
    v_lshl_add_u32 v10, v137, 14, v136
    v_add_u32 v10, s57, v10
    v_lshl_add_u32 v11, v137, 11, v136
    s_lshl_b32 s57, s3, 9
    s_add_u32 s57, s57, 147456
    v_add_u32 v11, s57, v11
    s_mul_i32 s57, s3, 3584
    v_add_u32 v136, s57, v3
    v_add_u32 v137, 2048, v136
    v_lshrrev_b32 v139, 11, v137
    v_lshlrev_b32 v139, 2, v139
    v_bfe_u32 v139, s96, v139, 3
    v_and_b32 v137, 0x7ff, v137
    v_lshl_add_u32 v137, v139, 11, v137
    s_add_u32 s1, s0, 4096
    v_add_u32 v6, s1, v137
    v_add_u32 v137, 3072, v136
    v_lshrrev_b32 v139, 11, v137
    v_lshlrev_b32 v139, 2, v139
    v_bfe_u32 v139, s96, v139, 3
    v_and_b32 v137, 0x7ff, v137
    v_lshl_add_u32 v137, v139, 11, v137
    s_add_u32 s1, s0, 3072
    v_add_u32 v7, s1, v137
    v_add_u32 v137, 4096, v136
    v_lshrrev_b32 v139, 11, v137
    v_lshlrev_b32 v139, 2, v139
    v_bfe_u32 v139, s96, v139, 3
    v_and_b32 v137, 0x7ff, v137
    v_lshl_add_u32 v137, v139, 11, v137
    s_add_u32 s1, s0, 2048
    v_add_u32 v8, s1, v137
    v_add_u32 v137, 5120, v136
    v_lshrrev_b32 v139, 11, v137
    v_lshlrev_b32 v139, 2, v139
    v_bfe_u32 v139, s96, v139, 3
    v_and_b32 v137, 0x7ff, v137
    v_lshl_add_u32 v137, v139, 11, v137
    s_add_u32 s1, s0, 1024
    v_add_u32 v9, s1, v137
    v_lshlrev_b32 v136, 4, v1
    v_add_u32 v12, 157696, v136
    v_lshlrev_b32 v137, 4, v2
    v_add_u32 v13, 158976, v137
    s_mul_i32 s0, s4, 3072
    s_add_u32 s0, s0, s100
    s_lshl_b32 s1, s3, 8
    s_add_u32 s1, s1, s0
    v_add_u32 v14, s1, v136
    v_and_b32 v137, 31, v0
    v_lshl_add_u32 v15, v137, 2, s101
    s_lshl_b32 s1, s3, 10
    s_add_u32 s0, s0, s1
    s_cmp_eq_u32 s3, 3
    s_cselect_b32 s1, 8, 7
    s_cselect_b32 s57, s101, s0
    v_lshlrev_b32 v91, s1, v0
    v_add_u32 v91, s57, v91
    s_lshl_b32 s1, s7, 10
    s_add_u32 s1, s1, 6225920
    s_cmp_lt_i32 s7, 0
    s_cselect_b32 s1, 8388608, s1
    s_cmp_eq_u32 s3, 3
    s_cselect_b32 s0, s1, s0
    v_add_u32 v95, s0, v3
    v_lshlrev_b32 v137, 8, v134
    v_lshl_add_u32 v137, v135, 4, v137
    v_add_u32 v137, s101, v137
    s_lshl2_add_u32 s0, s4, s3
    s_cmp_eq_u32 s0, 3
    s_cselect_b64 vcc, -1, 0
    v_cndmask_b32 v95, v95, v137, vcc
    v_mov_b32 v122, 0
    v_mov_b32 v123, 0
    s_lshl_b32 s0, s3, 8
    v_add_u32 v98, s0, v12
    v_lshlrev_b32 v101, 2, v1
    v_add_u32 v101, 158976, v101
    s_lshl_b32 s0, s3, 6
    s_add_u32 s0, s0, 64
    v_add_u32 v99, s0, v101
    v_lshlrev_b32 v254, 2, v0
    v_mov_b32 v248, -1
    v_mov_b32 v249, -1
    v_mov_b32 v250, -1
    v_mov_b32 v251, -1
    buffer_store_dwordx4 v[248:251], v95, s[20:23], 0 offen sc1
    v_lshlrev_b32 v136, 2, v2
    v_sub_u32 v136, v1, v136
    v_mov_b32 v137, 0xf149f2ca
    v_mov_b32 v140, 0xffff
    v_mov_b32 v141, 0xffff0000
    s_and_b32 s0, s5, 15
    s_cmp_eq_u32 s0, 0
    s_cselect_b64 s[50:51], -1, 0
    v_subrev_u32 v138, 0, v136
    v_cmp_gt_u32 vcc, 8, v138
    v_cmp_gt_i32 s[0:1], -8, v138
    v_cmp_le_i32 s[56:57], 0, v138
    v_cndmask_b32 v20, v137, 0, vcc
    v_cndmask_b32 v24, v137, 0, s[0:1]
    v_cndmask_b32 v18, 0, v140, s[56:57]
    v_subrev_u32 v138, 1, v136
    v_cmp_gt_u32 vcc, 8, v138
    v_cmp_gt_i32 s[0:1], -8, v138
    v_cmp_le_i32 s[56:57], 0, v138
    v_cndmask_b32 v21, v137, 0, vcc
    v_cndmask_b32 v25, v137, 0, s[0:1]
    v_cndmask_b32 v139, 0, v141, s[56:57]
    v_or_b32 v18, v18, v139
    v_subrev_u32 v138, 2, v136
    v_cmp_gt_u32 vcc, 8, v138
    v_cmp_gt_i32 s[0:1], -8, v138
    v_cmp_le_i32 s[56:57], 0, v138
    v_cndmask_b32 v22, v137, 0, vcc
    v_cndmask_b32 v26, v137, 0, s[0:1]
    v_cndmask_b32 v19, 0, v140, s[56:57]
    v_subrev_u32 v138, 3, v136
    v_cmp_gt_u32 vcc, 8, v138
    v_cmp_gt_i32 s[0:1], -8, v138
    v_cmp_le_i32 s[56:57], 0, v138
    v_cndmask_b32 v23, v137, 0, vcc
    v_cndmask_b32 v27, v137, 0, s[0:1]
    v_cndmask_b32 v139, 0, v141, s[56:57]
    v_or_b32 v19, v19, v139
    buffer_load_dwordx4 v75, s[12:15], s68 offen offset:2048 lds
    s_add_u32 m0, s67, 3072
    s_nop 0
    buffer_load_dwordx4 v76, s[12:15], s68 offen offset:0 lds
    buffer_load_dwordx4 v76, s[12:15], s68 offen offset:1024 lds
    buffer_load_dwordx4 v76, s[12:15], s68 offen offset:2048 lds
    s_mov_b64 exec, 0xffff
    global_load_dword v17, v253, s[70:71]
    s_mov_b64 exec, -1
    s_and_b32 s55, s4, 3
    s_mov_b32 s70, -1
    s_mov_b32 s71, 0x80000fff
    s_mov_b32 s56, 0
    s_mov_b32 s57, 0x80000000
    s_bfe_u32 s59, s96, 0x30008
    s_add_u32 m0, s66, 20480
    v_lshl_add_u32 v72, s59, 7, v73
    s_mov_b32 exec_lo, s6
    buffer_load_dwordx4 v72, s[8:11], s61 offen lds
    s_mov_b32 exec_lo, -1
    s_add_u32 m0, s66, 24576
    s_nop 0
    buffer_load_dwordx4 v72, s[8:11], s62 offen lds
    s_bfe_u32 s59, s97, 0x30008
    s_add_u32 m0, s66, 28672
    v_lshl_add_u32 v72, s59, 7, v73
    s_mov_b32 exec_lo, s54
    buffer_load_dwordx4 v72, s[8:11], s63 offen lds
    s_mov_b32 exec_lo, -1
    s_bfe_u32 s59, s96, 0x3000c
    s_add_u32 m0, s66, 32768
    v_lshl_add_u32 v72, s59, 7, v73
    buffer_load_dwordx4 v72, s[8:11], s64 offen lds
    s_add_u32 m0, s66, 36864
    s_nop 0
    buffer_load_dwordx4 v72, s[8:11], s65 offen lds
    s_waitcnt vmcnt(13)
    s_barrier
    ds_read_b128 v[50:53], v85 offset:0
    ds_read_b128 v[54:57], v86 offset:0
    ds_read_b128 v[58:61], v85 offset:10240
    ds_read_b128 v[62:65], v86 offset:10240
    ds_read_b128 v[66:69], v79 offset:0
    ds_read_b128 v[174:177], v80 offset:0
    ds_read_b128 v[178:181], v79 offset:10240
    ds_read_b128 v[182:185], v80 offset:10240
    s_waitcnt lgkmcnt(6)
    v_mfma_f32_16x16x32_bf16 v[102:105], v[46:49], v[50:53], 0
    ds_read_b128 v[134:137], v79 offset:0
    s_bfe_u32 s68, s96, 0x30004
    v_mfma_f32_16x16x32_bf16 v[106:109], v[50:53], v[50:53], 0
    ds_read_b128 v[138:141], v79 offset:2048
    s_mul_i32 s68, s68, 196608
    v_mfma_f32_16x16x32_bf16 v[102:105], v[46:49], v[54:57], v[102:105]
    ds_read_b128 v[142:145], v79 offset:4096
    s_add_u32 m0, s67, 24576
    v_mfma_f32_16x16x32_bf16 v[106:109], v[54:57], v[54:57], v[106:109]
    buffer_load_dwordx4 v75, s[12:15], s68 offen offset:0 lds
    s_waitcnt lgkmcnt(7)
    v_mfma_f32_16x16x32_bf16 v[102:105], v[46:49], v[58:61], v[102:105]
    ds_read_b128 v[146:149], v79 offset:6144
    v_mfma_f32_16x16x32_bf16 v[106:109], v[58:61], v[58:61], v[106:109]
    buffer_load_dwordx4 v75, s[12:15], s68 offen offset:1024 lds
    v_mfma_f32_16x16x32_bf16 v[102:105], v[46:49], v[62:65], v[102:105]
    ds_read_b128 v[150:153], v79 offset:8192
    v_mfma_f32_16x16x32_bf16 v[106:109], v[62:65], v[62:65], v[106:109]
    buffer_load_dwordx4 v75, s[12:15], s68 offen offset:2048 lds
    s_waitcnt lgkmcnt(5)
    v_mfma_f32_16x16x32_bf16 v[116:119], v[66:69], v[66:69], 0
    ds_read_b128 v[154:157], v80 offset:0
    s_add_u32 m0, s67, 27648
    v_mfma_f32_16x16x32_bf16 v[116:119], v[174:177], v[174:177], v[116:119]
    buffer_load_dwordx4 v76, s[12:15], s68 offen offset:0 lds
    v_mfma_f32_16x16x32_bf16 v[116:119], v[178:181], v[178:181], v[116:119]
    ds_read_b128 v[158:161], v80 offset:2048
    v_mfma_f32_16x16x32_bf16 v[116:119], v[182:185], v[182:185], v[116:119]
    buffer_load_dwordx4 v76, s[12:15], s68 offen offset:1024 lds
    ds_read_b128 v[162:165], v80 offset:4096
    ds_read_b128 v[166:169], v80 offset:6144
    ds_read_b128 v[170:173], v80 offset:8192
    buffer_load_dwordx4 v76, s[12:15], s68 offen offset:2048 lds
    s_bfe_u32 s68, s96, 0x30008
    s_mul_i32 s68, s68, 196608
    s_add_u32 m0, s67, 49152
    s_waitcnt vmcnt(12)
    s_barrier
    ds_read_b64_tr_b16 a[0:1], v83 offset:0
    ds_read_b64_tr_b16 a[2:3], v83 offset:512
    ds_read_b64_tr_b16 a[4:5], v83 offset:1024
    ds_read_b64_tr_b16 a[6:7], v83 offset:1536
    ds_read_b64_tr_b16 a[8:9], v83 offset:2048
    ds_read_b64_tr_b16 a[10:11], v83 offset:2560
    s_waitcnt lgkmcnt(4)
    v_mfma_f32_16x16x32_bf16 v[186:189], a[0:3], v[134:137], 0
    buffer_load_dwordx4 v75, s[12:15], s68 offen offset:0 lds
    v_mfma_f32_16x16x32_bf16 v[198:201], a[0:3], v[138:141], 0
    ds_read_b64_tr_b16 a[12:13], v83 offset:12288
    ds_read_b64_tr_b16 a[14:15], v83 offset:12800
    v_mfma_f32_16x16x32_bf16 v[210:213], a[0:3], v[142:145], 0
    ds_read_b64_tr_b16 a[16:17], v83 offset:13312
    ds_read_b64_tr_b16 a[18:19], v83 offset:13824
    v_mfma_f32_16x16x32_bf16 v[222:225], a[0:3], v[146:149], 0
    buffer_load_dwordx4 v75, s[12:15], s68 offen offset:1024 lds
    v_mfma_f32_16x16x32_bf16 v[234:237], a[0:3], v[150:153], 0
    ds_read_b64_tr_b16 a[20:21], v83 offset:14336
    s_waitcnt lgkmcnt(7)
    v_mfma_f32_16x16x32_bf16 v[190:193], a[4:7], v[134:137], 0
    ds_read_b64_tr_b16 a[22:23], v83 offset:14848
    v_mfma_f32_16x16x32_bf16 v[202:205], a[4:7], v[138:141], 0
    buffer_load_dwordx4 v75, s[12:15], s68 offen offset:2048 lds
    v_mfma_f32_16x16x32_bf16 v[214:217], a[4:7], v[142:145], 0
    s_add_u32 m0, s67, 52224
    v_mfma_f32_16x16x32_bf16 v[226:229], a[4:7], v[146:149], 0
    v_mfma_f32_16x16x32_bf16 v[238:241], a[4:7], v[150:153], 0
    s_waitcnt lgkmcnt(6)
    v_mfma_f32_16x16x32_bf16 v[194:197], v[134:137], a[8:11], 0
    buffer_load_dwordx4 v76, s[12:15], s68 offen offset:0 lds
    v_mfma_f32_16x16x32_bf16 v[206:209], v[138:141], a[8:11], 0
    v_mfma_f32_16x16x32_bf16 v[218:221], v[142:145], a[8:11], 0
    v_mfma_f32_16x16x32_bf16 v[230:233], v[146:149], a[8:11], 0
    buffer_load_dwordx4 v76, s[12:15], s68 offen offset:1024 lds
    v_mfma_f32_16x16x32_bf16 v[242:245], v[150:153], a[8:11], 0
    s_waitcnt lgkmcnt(0)
    v_mfma_f32_16x16x32_bf16 v[186:189], a[12:15], v[154:157], v[186:189]
    ds_read_b128 v[134:137], v79 offset:10240
    global_load_dwordx4 v[38:41], v92, s[42:43] offset:0
    v_mfma_f32_16x16x32_bf16 v[190:193], a[16:19], v[154:157], v[190:193]
    buffer_load_dwordx4 v76, s[12:15], s68 offen offset:2048 lds
    v_mfma_f32_16x16x32_bf16 v[194:197], v[154:157], a[20:23], v[194:197]
    ds_read_b128 v[138:141], v79 offset:12288
    s_bfe_u32 s59, s96, 0x30010
    v_mfma_f32_16x16x32_bf16 v[198:201], a[12:15], v[158:161], v[198:201]
    s_add_u32 m0, s66, 40960
    v_lshl_add_u32 v72, s59, 7, v73
    s_waitcnt vmcnt(7)
    s_barrier
    s_lshl2_add_u32 s0, s4, s3
    s_cmp_eq_u32 s0, 3
    s_cbranch_scc0 L_go_1
    s_lshl_b32 s1, s5, 3
    s_atomic_add s0, s[40:41], s1
L_go_1:
    v_mfma_f32_16x16x32_bf16 v[202:205], a[16:19], v[158:161], v[202:205]
    s_mov_b32 exec_lo, s6
    buffer_load_dwordx4 v72, s[8:11], s61 offen lds
    s_mov_b32 exec_lo, -1
    v_mfma_f32_16x16x32_bf16 v[206:209], v[158:161], a[20:23], v[206:209]
    ds_read_b64_tr_b16 a[24:25], v83 offset:24576
    v_mfma_f32_16x16x32_bf16 v[210:213], a[12:15], v[162:165], v[210:213]
    ds_read_b64_tr_b16 a[26:27], v83 offset:25088
    s_add_u32 m0, s66, 45056
    v_mfma_f32_16x16x32_bf16 v[214:217], a[16:19], v[162:165], v[214:217]
    buffer_load_dwordx4 v72, s[8:11], s62 offen lds
    v_mfma_f32_16x16x32_bf16 v[218:221], v[162:165], a[20:23], v[218:221]
    ds_read_b128 v[142:145], v79 offset:14336
    s_bfe_u32 s59, s97, 0x30010
    v_mfma_f32_16x16x32_bf16 v[222:225], a[12:15], v[166:169], v[222:225]
    ds_read_b128 v[146:149], v79 offset:16384
    s_add_u32 m0, s66, 49152
    v_mfma_f32_16x16x32_bf16 v[226:229], a[16:19], v[166:169], v[226:229]
    ds_read_b128 v[150:153], v79 offset:18432
    v_lshl_add_u32 v72, s59, 7, v73
    v_mfma_f32_16x16x32_bf16 v[230:233], v[166:169], a[20:23], v[230:233]
    s_mov_b32 exec_lo, s54
    buffer_load_dwordx4 v72, s[8:11], s63 offen lds
    s_mov_b32 exec_lo, -1
    v_mfma_f32_16x16x32_bf16 v[234:237], a[12:15], v[170:173], v[234:237]
    ds_read_b64_tr_b16 a[28:29], v83 offset:25600
    s_bfe_u32 s59, s96, 0x30014
    v_mfma_f32_16x16x32_bf16 v[238:241], a[16:19], v[170:173], v[238:241]
    ds_read_b64_tr_b16 a[30:31], v83 offset:26112
    s_add_u32 m0, s66, 53248
    v_mfma_f32_16x16x32_bf16 v[242:245], v[170:173], a[20:23], v[242:245]
    ds_read_b64_tr_b16 a[32:33], v83 offset:26624
    s_waitcnt lgkmcnt(3)
    v_mfma_f32_16x16x32_bf16 v[186:189], a[24:27], v[134:137], v[186:189]
    ds_read_b64_tr_b16 a[34:35], v83 offset:27136
    v_lshl_add_u32 v72, s59, 7, v73
    v_mfma_f32_16x16x32_bf16 v[198:201], a[24:27], v[138:141], v[198:201]
    buffer_load_dwordx4 v72, s[8:11], s64 offen lds
    v_mfma_f32_16x16x32_bf16 v[210:213], a[24:27], v[142:145], v[210:213]
    ds_read_b64_tr_b16 a[36:37], v83 offset:36864
    ds_read_b64_tr_b16 a[38:39], v83 offset:37376
    v_mfma_f32_16x16x32_bf16 v[222:225], a[24:27], v[146:149], v[222:225]
    ds_read_b64_tr_b16 a[40:41], v83 offset:37888
    s_add_u32 m0, s66, 57344
    v_mfma_f32_16x16x32_bf16 v[234:237], a[24:27], v[150:153], v[234:237]
    ds_read_b64_tr_b16 a[42:43], v83 offset:38400
    s_waitcnt lgkmcnt(6)
    v_mfma_f32_16x16x32_bf16 v[190:193], a[28:31], v[134:137], v[190:193]
    buffer_load_dwordx4 v72, s[8:11], s65 offen lds
    v_mfma_f32_16x16x32_bf16 v[202:205], a[28:31], v[138:141], v[202:205]
    ds_read_b64_tr_b16 a[44:45], v83 offset:38912
    s_bfe_u32 s68, s96, 0x3000c
    v_mfma_f32_16x16x32_bf16 v[214:217], a[28:31], v[142:145], v[214:217]
    ds_read_b64_tr_b16 a[46:47], v83 offset:39424
    s_mul_i32 s68, s68, 196608
    v_mfma_f32_16x16x32_bf16 v[226:229], a[28:31], v[146:149], v[226:229]
    ds_read_b128 v[50:53], v85 offset:20480
    s_add_u32 m0, s67, 0
    v_mfma_f32_16x16x32_bf16 v[238:241], a[28:31], v[150:153], v[238:241]
    ds_read_b128 v[54:57], v86 offset:20480
    s_waitcnt lgkmcnt(8)
    v_mfma_f32_16x16x32_bf16 v[194:197], v[134:137], a[32:35], v[194:197]
    buffer_load_dwordx4 v75, s[12:15], s68 offen offset:0 lds
    v_mfma_f32_16x16x32_bf16 v[206:209], v[138:141], a[32:35], v[206:209]
    ds_read_b128 v[58:61], v85 offset:30720
    global_load_dwordx4 v[42:45], v92, s[42:43] offset:64
    v_mfma_f32_16x16x32_bf16 v[218:221], v[142:145], a[32:35], v[218:221]
    ds_read_b128 v[62:65], v86 offset:30720
    v_mfma_f32_16x16x32_bf16 v[230:233], v[146:149], a[32:35], v[230:233]
    buffer_load_dwordx4 v75, s[12:15], s68 offen offset:1024 lds
    v_mfma_f32_16x16x32_bf16 v[242:245], v[150:153], a[32:35], v[242:245]
    ds_read_b128 v[66:69], v79 offset:20480
    s_waitcnt lgkmcnt(3)
    v_mfma_f32_16x16x32_bf16 v[102:105], v[46:49], v[50:53], v[102:105]
    ds_read_b128 v[174:177], v80 offset:20480
    v_mfma_f32_16x16x32_bf16 v[106:109], v[50:53], v[50:53], v[106:109]
    buffer_load_dwordx4 v75, s[12:15], s68 offen offset:2048 lds
    v_mfma_f32_16x16x32_bf16 v[102:105], v[46:49], v[54:57], v[102:105]
    ds_read_b128 v[178:181], v79 offset:30720
    s_add_u32 m0, s67, 3072
    v_mfma_f32_16x16x32_bf16 v[106:109], v[54:57], v[54:57], v[106:109]
    ds_read_b128 v[182:185], v80 offset:30720
    s_waitcnt lgkmcnt(4)
    v_mfma_f32_16x16x32_bf16 v[102:105], v[46:49], v[58:61], v[102:105]
    buffer_load_dwordx4 v76, s[12:15], s68 offen offset:0 lds
    v_mfma_f32_16x16x32_bf16 v[106:109], v[58:61], v[58:61], v[106:109]
    ds_read_b128 v[154:157], v80 offset:10240
    v_mfma_f32_16x16x32_bf16 v[102:105], v[46:49], v[62:65], v[102:105]
    ds_read_b128 v[158:161], v80 offset:12288
    v_mfma_f32_16x16x32_bf16 v[106:109], v[62:65], v[62:65], v[106:109]
    ds_read_b128 v[162:165], v80 offset:14336
    s_waitcnt lgkmcnt(3)
    v_mfma_f32_16x16x32_bf16 v[116:119], v[66:69], v[66:69], v[116:119]
    buffer_load_dwordx4 v76, s[12:15], s68 offen offset:1024 lds
    v_mfma_f32_16x16x32_bf16 v[116:119], v[174:177], v[174:177], v[116:119]
    ds_read_b128 v[166:169], v80 offset:16384
    v_mfma_f32_16x16x32_bf16 v[116:119], v[178:181], v[178:181], v[116:119]
    ds_read_b128 v[170:173], v80 offset:18432
    v_mfma_f32_16x16x32_bf16 v[116:119], v[182:185], v[182:185], v[116:119]
    s_waitcnt lgkmcnt(3)
    v_mfma_f32_16x16x32_bf16 v[186:189], a[36:39], v[154:157], v[186:189]
    buffer_load_dwordx4 v76, s[12:15], s68 offen offset:2048 lds
    v_mfma_f32_16x16x32_bf16 v[190:193], a[40:43], v[154:157], v[190:193]
    ds_read_b128 v[134:137], v79 offset:20480
    s_bfe_u32 s68, s96, 0x30010
    v_mfma_f32_16x16x32_bf16 v[194:197], v[154:157], a[44:47], v[194:197]
    ds_read_b128 v[138:141], v79 offset:22528
    s_mul_i32 s68, s68, 196608
    v_mfma_f32_16x16x32_bf16 v[198:201], a[36:39], v[158:161], v[198:201]
    s_add_u32 m0, s67, 24576
    s_waitcnt vmcnt(12)
    s_barrier
    v_mfma_f32_16x16x32_bf16 v[202:205], a[40:43], v[158:161], v[202:205]
    buffer_load_dwordx4 v75, s[12:15], s68 offen offset:0 lds
    v_mfma_f32_16x16x32_bf16 v[206:209], v[158:161], a[44:47], v[206:209]
    ds_read_b64_tr_b16 a[48:49], v83 offset:49152
    s_waitcnt lgkmcnt(3)
    v_mfma_f32_16x16x32_bf16 v[210:213], a[36:39], v[162:165], v[210:213]
    ds_read_b64_tr_b16 a[50:51], v83 offset:49664
    ds_read_b128 v[142:145], v79 offset:24576
    v_mfma_f32_16x16x32_bf16 v[214:217], a[40:43], v[162:165], v[214:217]
    buffer_load_dwordx4 v75, s[12:15], s68 offen offset:1024 lds
    v_mfma_f32_16x16x32_bf16 v[218:221], v[162:165], a[44:47], v[218:221]
    ds_read_b128 v[146:149], v79 offset:26624
    v_mfma_f32_16x16x32_bf16 v[222:225], a[36:39], v[166:169], v[222:225]
    ds_read_b128 v[150:153], v79 offset:28672
    ds_read_b64_tr_b16 a[52:53], v83 offset:50176
    v_mfma_f32_16x16x32_bf16 v[226:229], a[40:43], v[166:169], v[226:229]
    buffer_load_dwordx4 v75, s[12:15], s68 offen offset:2048 lds
    v_mfma_f32_16x16x32_bf16 v[230:233], v[166:169], a[44:47], v[230:233]
    ds_read_b64_tr_b16 a[54:55], v83 offset:50688
    ds_read_b64_tr_b16 a[56:57], v83 offset:51200
    v_mfma_f32_16x16x32_bf16 v[234:237], a[36:39], v[170:173], v[234:237]
    ds_read_b64_tr_b16 a[58:59], v83 offset:51712
    s_add_u32 m0, s67, 27648
    v_mfma_f32_16x16x32_bf16 v[238:241], a[40:43], v[170:173], v[238:241]
    buffer_load_dwordx4 v76, s[12:15], s68 offen offset:0 lds
    v_mfma_f32_16x16x32_bf16 v[242:245], v[170:173], a[44:47], v[242:245]
    ds_read_b64_tr_b16 a[60:61], v83 offset:61440
    s_waitcnt lgkmcnt(5)
    v_mfma_f32_16x16x32_bf16 v[186:189], a[48:51], v[134:137], v[186:189]
    ds_read_b64_tr_b16 a[62:63], v83 offset:61952
    ds_read_b64_tr_b16 a[64:65], v83 offset:62464
    v_mfma_f32_16x16x32_bf16 v[198:201], a[48:51], v[138:141], v[198:201]
    buffer_load_dwordx4 v76, s[12:15], s68 offen offset:1024 lds
    v_mfma_f32_16x16x32_bf16 v[210:213], a[48:51], v[142:145], v[210:213]
    ds_read_b64_tr_b16 a[66:67], v83 offset:62976
    ds_read_b64_tr_b16 a[68:69], v83 offset:63488
    v_mfma_f32_16x16x32_bf16 v[222:225], a[48:51], v[146:149], v[222:225]
    ds_read_b64_tr_b16 a[70:71], v83 offset:64000
    ds_read_b128 v[154:157], v80 offset:20480
    v_mfma_f32_16x16x32_bf16 v[234:237], a[48:51], v[150:153], v[234:237]
    ds_read_b128 v[158:161], v80 offset:22528
    s_waitcnt lgkmcnt(10)
    v_mfma_f32_16x16x32_bf16 v[190:193], a[52:55], v[134:137], v[190:193]
    buffer_load_dwordx4 v76, s[12:15], s68 offen offset:2048 lds
    v_mfma_f32_16x16x32_bf16 v[202:205], a[52:55], v[138:141], v[202:205]
    ds_read_b128 v[162:165], v80 offset:24576
    v_mfma_f32_16x16x32_bf16 v[214:217], a[52:55], v[142:145], v[214:217]
    ds_read_b128 v[166:169], v80 offset:26624
    v_mfma_f32_16x16x32_bf16 v[226:229], a[52:55], v[146:149], v[226:229]
    s_cmp_eq_u32 s55, 0
    s_cselect_b64 exec, s[70:71], s[56:57]
    global_load_dword v17, v[70:71], off
    s_mov_b64 exec, -1
    v_mfma_f32_16x16x32_bf16 v[238:241], a[52:55], v[150:153], v[238:241]
    ds_read_b128 v[170:173], v80 offset:28672
    s_waitcnt lgkmcnt(11)
    v_mfma_f32_16x16x32_bf16 v[194:197], v[134:137], a[56:59], v[194:197]
    s_bfe_u32 s59, s96, 0x30018
    s_add_u32 m0, s66, 61440
    v_mfma_f32_16x16x32_bf16 v[206:209], v[138:141], a[56:59], v[206:209]
    v_lshl_add_u32 v72, s59, 7, v73
    v_mfma_f32_16x16x32_bf16 v[218:221], v[142:145], a[56:59], v[218:221]
    s_mov_b32 exec_lo, s6
    buffer_load_dwordx4 v72, s[8:11], s61 offen lds
    s_mov_b32 exec_lo, -1
    v_mfma_f32_16x16x32_bf16 v[230:233], v[146:149], a[56:59], v[230:233]
    s_add_u32 m0, s66, 65536
    v_mfma_f32_16x16x32_bf16 v[242:245], v[150:153], a[56:59], v[242:245]
    s_waitcnt lgkmcnt(3)
    v_mfma_f32_16x16x32_bf16 v[186:189], a[60:63], v[154:157], v[186:189]
    buffer_load_dwordx4 v72, s[8:11], s62 offen lds
    v_mfma_f32_16x16x32_bf16 v[190:193], a[64:67], v[154:157], v[190:193]
    ds_read_b128 v[134:137], v79 offset:30720
    s_bfe_u32 s59, s97, 0x30018
    v_mfma_f32_16x16x32_bf16 v[194:197], v[154:157], a[68:71], v[194:197]
    ds_read_b128 v[138:141], v79 offset:32768
    s_add_u32 m0, s66, 69632
    v_mfma_f32_16x16x32_bf16 v[198:201], a[60:63], v[158:161], v[198:201]
    v_lshl_add_u32 v72, s59, 7, v73
    s_waitcnt vmcnt(9)
    s_barrier
    v_mfma_f32_16x16x32_bf16 v[202:205], a[64:67], v[158:161], v[202:205]
    s_mov_b32 exec_lo, s54
    buffer_load_dwordx4 v72, s[8:11], s63 offen lds
    s_mov_b32 exec_lo, -1
    v_mfma_f32_16x16x32_bf16 v[206:209], v[158:161], a[68:71], v[206:209]
    ds_read_b64_tr_b16 a[72:73], v83 offset:0
    s_waitcnt lgkmcnt(3)
    v_mfma_f32_16x16x32_bf16 v[210:213], a[60:63], v[162:165], v[210:213]
    ds_read_b64_tr_b16 a[74:75], v83 offset:512
    s_bfe_u32 s59, s96, 0x3001c
    v_mfma_f32_16x16x32_bf16 v[214:217], a[64:67], v[162:165], v[214:217]
    ds_read_b128 v[142:145], v79 offset:34816
    s_add_u32 m0, s66, 73728
    v_mfma_f32_16x16x32_bf16 v[218:221], v[162:165], a[68:71], v[218:221]
    ds_read_b128 v[146:149], v79 offset:36864
    v_lshl_add_u32 v72, s59, 7, v73
    v_mfma_f32_16x16x32_bf16 v[222:225], a[60:63], v[166:169], v[222:225]
    buffer_load_dwordx4 v72, s[8:11], s64 offen lds
    v_mfma_f32_16x16x32_bf16 v[226:229], a[64:67], v[166:169], v[226:229]
    ds_read_b128 v[150:153], v79 offset:38912
    ds_read_b64_tr_b16 a[76:77], v83 offset:1024
    v_mfma_f32_16x16x32_bf16 v[230:233], v[166:169], a[68:71], v[230:233]
    ds_read_b64_tr_b16 a[78:79], v83 offset:1536
    s_add_u32 m0, s66, 77824
    v_mfma_f32_16x16x32_bf16 v[234:237], a[60:63], v[170:173], v[234:237]
    buffer_load_dwordx4 v72, s[8:11], s65 offen lds
    v_mfma_f32_16x16x32_bf16 v[238:241], a[64:67], v[170:173], v[238:241]
    ds_read_b64_tr_b16 a[80:81], v83 offset:2048
    s_bfe_u32 s68, s96, 0x30014
    v_mfma_f32_16x16x32_bf16 v[242:245], v[170:173], a[68:71], v[242:245]
    ds_read_b64_tr_b16 a[82:83], v83 offset:2560
    s_waitcnt lgkmcnt(4)
    v_mfma_f32_16x16x32_bf16 v[186:189], a[72:75], v[134:137], v[186:189]
    ds_read_b64_tr_b16 a[84:85], v83 offset:12288
    s_mul_i32 s68, s68, 196608
    v_mfma_f32_16x16x32_bf16 v[198:201], a[72:75], v[138:141], v[198:201]
    ds_read_b64_tr_b16 a[86:87], v83 offset:12800
    s_add_u32 m0, s67, 49152
    v_mfma_f32_16x16x32_bf16 v[210:213], a[72:75], v[142:145], v[210:213]
    buffer_load_dwordx4 v75, s[12:15], s68 offen offset:0 lds
    v_mfma_f32_16x16x32_bf16 v[222:225], a[72:75], v[146:149], v[222:225]
    ds_read_b64_tr_b16 a[88:89], v83 offset:13312
    ds_read_b64_tr_b16 a[90:91], v83 offset:13824
    v_mfma_f32_16x16x32_bf16 v[234:237], a[72:75], v[150:153], v[234:237]
    ds_read_b64_tr_b16 a[92:93], v83 offset:14336
    s_waitcnt lgkmcnt(7)
    v_mfma_f32_16x16x32_bf16 v[190:193], a[76:79], v[134:137], v[190:193]
    buffer_load_dwordx4 v75, s[12:15], s68 offen offset:1024 lds
    v_mfma_f32_16x16x32_bf16 v[202:205], a[76:79], v[138:141], v[202:205]
    ds_read_b64_tr_b16 a[94:95], v83 offset:14848
    ds_read_b128 v[50:53], v87 offset:0
    v_mfma_f32_16x16x32_bf16 v[214:217], a[76:79], v[142:145], v[214:217]
    ds_read_b128 v[54:57], v88 offset:0
    v_mfma_f32_16x16x32_bf16 v[226:229], a[76:79], v[146:149], v[226:229]
    buffer_load_dwordx4 v75, s[12:15], s68 offen offset:2048 lds
    v_mfma_f32_16x16x32_bf16 v[238:241], a[76:79], v[150:153], v[238:241]
    ds_read_b128 v[58:61], v87 offset:10240
    s_waitcnt lgkmcnt(9)
    v_mfma_f32_16x16x32_bf16 v[194:197], v[134:137], a[80:83], v[194:197]
    ds_read_b128 v[62:65], v88 offset:10240
    s_add_u32 m0, s67, 52224
    v_mfma_f32_16x16x32_bf16 v[206:209], v[138:141], a[80:83], v[206:209]
    buffer_load_dwordx4 v76, s[12:15], s68 offen offset:0 lds
    v_mfma_f32_16x16x32_bf16 v[218:221], v[142:145], a[80:83], v[218:221]
    ds_read_b128 v[66:69], v81 offset:0
    v_mfma_f32_16x16x32_bf16 v[230:233], v[146:149], a[80:83], v[230:233]
    ds_read_b128 v[174:177], v82 offset:0
    v_mfma_f32_16x16x32_bf16 v[242:245], v[150:153], a[80:83], v[242:245]
    ds_read_b128 v[178:181], v81 offset:10240
    s_waitcnt lgkmcnt(5)
    v_mfma_f32_16x16x32_bf16 v[102:105], v[46:49], v[50:53], v[102:105]
    buffer_load_dwordx4 v76, s[12:15], s68 offen offset:1024 lds
    v_mfma_f32_16x16x32_bf16 v[106:109], v[50:53], v[50:53], v[106:109]
    ds_read_b128 v[182:185], v82 offset:10240
    v_mfma_f32_16x16x32_bf16 v[102:105], v[46:49], v[54:57], v[102:105]
    ds_read_b128 v[154:157], v80 offset:30720
    v_mfma_f32_16x16x32_bf16 v[106:109], v[54:57], v[54:57], v[106:109]
    ds_read_b128 v[158:161], v80 offset:32768
    s_waitcnt lgkmcnt(6)
    v_mfma_f32_16x16x32_bf16 v[102:105], v[46:49], v[58:61], v[102:105]
    buffer_load_dwordx4 v76, s[12:15], s68 offen offset:2048 lds
    v_mfma_f32_16x16x32_bf16 v[106:109], v[58:61], v[58:61], v[106:109]
    ds_read_b128 v[162:165], v80 offset:34816
    v_mfma_f32_16x16x32_bf16 v[102:105], v[46:49], v[62:65], v[102:105]
    ds_read_b128 v[166:169], v80 offset:36864
    v_mfma_f32_16x16x32_bf16 v[106:109], v[62:65], v[62:65], v[106:109]
    ds_read_b128 v[170:173], v80 offset:38912
    s_waitcnt lgkmcnt(5)
    v_mfma_f32_16x16x32_bf16 v[116:119], v[66:69], v[66:69], v[116:119]
    s_cmp_eq_u32 s55, 1
    s_cselect_b64 exec, s[70:71], s[56:57]
    global_load_dword v17, v[70:71], off
    s_mov_b64 exec, -1
    v_mfma_f32_16x16x32_bf16 v[116:119], v[174:177], v[174:177], v[116:119]
    s_bfe_u32 s68, s96, 0x30018
    s_mul_i32 s68, s68, 196608
    v_mfma_f32_16x16x32_bf16 v[116:119], v[178:181], v[178:181], v[116:119]
    s_add_u32 m0, s67, 0
    v_mfma_f32_16x16x32_bf16 v[116:119], v[182:185], v[182:185], v[116:119]
    s_waitcnt lgkmcnt(3)
    v_mfma_f32_16x16x32_bf16 v[186:189], a[84:87], v[154:157], v[186:189]
    ds_read_b128 v[134:137], v81 offset:0
    v_mfma_f32_16x16x32_bf16 v[190:193], a[88:91], v[154:157], v[190:193]
    ds_read_b128 v[138:141], v81 offset:2048
    v_mfma_f32_16x16x32_bf16 v[194:197], v[154:157], a[92:95], v[194:197]
    ds_read_b128 v[142:145], v81 offset:4096
    v_mfma_f32_16x16x32_bf16 v[198:201], a[84:87], v[158:161], v[198:201]
    s_waitcnt vmcnt(13)
    s_barrier
    v_mfma_f32_16x16x32_bf16 v[202:205], a[88:91], v[158:161], v[202:205]
    buffer_load_dwordx4 v75, s[12:15], s68 offen offset:0 lds
    v_mfma_f32_16x16x32_bf16 v[206:209], v[158:161], a[92:95], v[206:209]
    ds_read_b64_tr_b16 a[96:97], v83 offset:24576
    s_waitcnt lgkmcnt(4)
    v_mfma_f32_16x16x32_bf16 v[210:213], a[84:87], v[162:165], v[210:213]
    ds_read_b64_tr_b16 a[98:99], v83 offset:25088
    ds_read_b128 v[146:149], v81 offset:6144
    v_mfma_f32_16x16x32_bf16 v[214:217], a[88:91], v[162:165], v[214:217]
    ds_read_b128 v[150:153], v81 offset:8192
    ds_read_b64_tr_b16 a[100:101], v83 offset:25600
    v_mfma_f32_16x16x32_bf16 v[218:221], v[162:165], a[92:95], v[218:221]
    buffer_load_dwordx4 v75, s[12:15], s68 offen offset:1024 lds
    v_mfma_f32_16x16x32_bf16 v[222:225], a[84:87], v[166:169], v[222:225]
    ds_read_b64_tr_b16 a[102:103], v83 offset:26112
    ds_read_b64_tr_b16 a[104:105], v83 offset:26624
    v_mfma_f32_16x16x32_bf16 v[226:229], a[88:91], v[166:169], v[226:229]
    ds_read_b64_tr_b16 a[106:107], v83 offset:27136
    ds_read_b64_tr_b16 a[108:109], v83 offset:36864
    v_mfma_f32_16x16x32_bf16 v[230:233], v[166:169], a[92:95], v[230:233]
    ds_read_b64_tr_b16 a[110:111], v83 offset:37376
    ds_read_b64_tr_b16 a[112:113], v83 offset:37888
    v_mfma_f32_16x16x32_bf16 v[234:237], a[84:87], v[170:173], v[234:237]
    buffer_load_dwordx4 v75, s[12:15], s68 offen offset:2048 lds
    v_mfma_f32_16x16x32_bf16 v[238:241], a[88:91], v[170:173], v[238:241]
    ds_read_b64_tr_b16 a[114:115], v83 offset:38400
    ds_read_b64_tr_b16 a[116:117], v83 offset:38912
    v_mfma_f32_16x16x32_bf16 v[242:245], v[170:173], a[92:95], v[242:245]
    ds_read_b64_tr_b16 a[118:119], v83 offset:39424
    s_waitcnt lgkmcnt(10)
    v_mfma_f32_16x16x32_bf16 v[186:189], a[96:99], v[134:137], v[186:189]
    ds_read_b128 v[154:157], v82 offset:0
    s_add_u32 m0, s67, 3072
    v_mfma_f32_16x16x32_bf16 v[198:201], a[96:99], v[138:141], v[198:201]
    buffer_load_dwordx4 v76, s[12:15], s68 offen offset:0 lds
    v_mfma_f32_16x16x32_bf16 v[210:213], a[96:99], v[142:145], v[210:213]
    ds_read_b128 v[158:161], v82 offset:2048
    v_mfma_f32_16x16x32_bf16 v[128:131], v[46:49], v[124:127], 0
    v_mfma_f32_16x16x32_bf16 v[222:225], a[96:99], v[146:149], v[222:225]
    ds_read_b128 v[162:165], v82 offset:4096
    v_cndmask_b32 v38, v46, v38, s[46:47]
    v_mfma_f32_16x16x32_bf16 v[234:237], a[96:99], v[150:153], v[234:237]
    ds_read_b128 v[166:169], v82 offset:6144
    s_waitcnt lgkmcnt(12)
    v_mfma_f32_16x16x32_bf16 v[190:193], a[100:103], v[134:137], v[190:193]
    buffer_load_dwordx4 v76, s[12:15], s68 offen offset:1024 lds
    v_mfma_f32_16x16x32_bf16 v[202:205], a[100:103], v[138:141], v[202:205]
    ds_read_b128 v[170:173], v82 offset:8192
    v_cndmask_b32 v39, v46, v39, s[46:47]
    v_mfma_f32_16x16x32_bf16 v[214:217], a[100:103], v[142:145], v[214:217]
    v_cndmask_b32 v40, v46, v40, s[46:47]
    v_cndmask_b32 v41, v46, v41, s[46:47]
    v_mfma_f32_16x16x32_bf16 v[226:229], a[100:103], v[146:149], v[226:229]
    v_cndmask_b32 v42, v46, v42, s[46:47]
    v_cndmask_b32 v43, v46, v43, s[46:47]
    v_mfma_f32_16x16x32_bf16 v[238:241], a[100:103], v[150:153], v[238:241]
    v_cndmask_b32 v44, v46, v44, s[46:47]
    s_waitcnt lgkmcnt(11)
    v_mfma_f32_16x16x32_bf16 v[194:197], v[134:137], a[104:107], v[194:197]
    buffer_load_dwordx4 v76, s[12:15], s68 offen offset:2048 lds
    v_mfma_f32_16x16x32_bf16 v[206:209], v[138:141], a[104:107], v[206:209]
    v_cndmask_b32 v45, v46, v45, s[46:47]
    v_add_f32_dpp v128, v128, v128 row_ror:8 row_mask:0xf bank_mask:0xf
    v_mfma_f32_16x16x32_bf16 v[218:221], v[142:145], a[104:107], v[218:221]
    s_nop 0
    v_add_f32_dpp v128, v128, v128 row_ror:4 row_mask:0xf bank_mask:0xf
    v_mfma_f32_16x16x32_bf16 v[230:233], v[146:149], a[104:107], v[230:233]
    s_nop 0
    v_add_f32_dpp v128, v128, v128 row_ror:2 row_mask:0xf bank_mask:0xf
    v_mfma_f32_16x16x32_bf16 v[242:245], v[150:153], a[104:107], v[242:245]
    s_nop 0
    s_waitcnt lgkmcnt(3)
    v_mfma_f32_16x16x32_bf16 v[186:189], a[108:111], v[154:157], v[186:189]
    s_cmp_eq_u32 s55, 2
    s_cselect_b64 exec, s[70:71], s[56:57]
    global_load_dword v17, v[70:71], off
    s_mov_b64 exec, -1
    v_mfma_f32_16x16x32_bf16 v[190:193], a[112:115], v[154:157], v[190:193]
    ds_read_b128 v[134:137], v81 offset:10240
    s_bfe_u32 s68, s96, 0x3001c
    v_mfma_f32_16x16x32_bf16 v[194:197], v[154:157], a[116:119], v[194:197]
    ds_read_b128 v[138:141], v81 offset:12288
    s_mul_i32 s68, s68, 196608
    v_mfma_f32_16x16x32_bf16 v[198:201], a[108:111], v[158:161], v[198:201]
    s_add_u32 m0, s67, 24576
    s_waitcnt vmcnt(8) lgkmcnt(2)
    s_barrier
    v_mfma_f32_16x16x32_bf16 v[202:205], a[112:115], v[158:161], v[202:205]
    buffer_load_dwordx4 v75, s[12:15], s68 offen offset:0 lds
    v_mfma_f32_16x16x32_bf16 v[206:209], v[158:161], a[116:119], v[206:209]
    ds_read_b64_tr_b16 a[120:121], v83 offset:49152
    v_mfma_f32_16x16x32_bf16 v[210:213], a[108:111], v[162:165], v[210:213]
    ds_read_b64_tr_b16 a[122:123], v83 offset:49664
    ds_read_b128 v[142:145], v81 offset:14336
    v_mfma_f32_16x16x32_bf16 v[214:217], a[112:115], v[162:165], v[214:217]
    ds_read_b128 v[146:149], v81 offset:16384
    v_add_f32_dpp v128, v128, v128 row_ror:1 row_mask:0xf bank_mask:0xf
    v_mfma_f32_16x16x32_bf16 v[218:221], v[162:165], a[116:119], v[218:221]
    buffer_load_dwordx4 v75, s[12:15], s68 offen offset:1024 lds
    v_mfma_f32_16x16x32_bf16 v[222:225], a[108:111], v[166:169], v[222:225]
    ds_read_b128 v[150:153], v81 offset:18432
    ds_read_b64_tr_b16 a[124:125], v83 offset:50176
    v_mfma_f32_16x16x32_bf16 v[226:229], a[112:115], v[166:169], v[226:229]
    ds_read_b64_tr_b16 a[126:127], v83 offset:50688
    ds_read_b64_tr_b16 a[128:129], v83 offset:51200
    v_mfma_f32_16x16x32_bf16 v[230:233], v[166:169], a[116:119], v[230:233]
    ds_read_b64_tr_b16 a[130:131], v83 offset:51712
    ds_read_b64_tr_b16 a[132:133], v83 offset:61440
    v_mfma_f32_16x16x32_bf16 v[234:237], a[108:111], v[170:173], v[234:237]
    buffer_load_dwordx4 v75, s[12:15], s68 offen offset:2048 lds
    v_mfma_f32_16x16x32_bf16 v[238:241], a[112:115], v[170:173], v[238:241]
    ds_read_b64_tr_b16 a[134:135], v83 offset:61952
    ds_read_b64_tr_b16 a[136:137], v83 offset:62464
    v_mfma_f32_16x16x32_bf16 v[242:245], v[170:173], a[116:119], v[242:245]
    ds_read_b64_tr_b16 a[138:139], v83 offset:62976
    s_waitcnt lgkmcnt(8)
    v_mfma_f32_16x16x32_bf16 v[186:189], a[120:123], v[134:137], v[186:189]
    ds_read_b64_tr_b16 a[140:141], v83 offset:63488
    s_add_u32 m0, s67, 27648
    v_mfma_f32_16x16x32_bf16 v[198:201], a[120:123], v[138:141], v[198:201]
    buffer_load_dwordx4 v76, s[12:15], s68 offen offset:0 lds
    v_mfma_f32_16x16x32_bf16 v[210:213], a[120:123], v[142:145], v[210:213]
    ds_read_b64_tr_b16 a[142:143], v83 offset:64000
    ds_read_b128 v[50:53], v87 offset:20480
    v_mfma_f32_16x16x32_bf16 v[222:225], a[120:123], v[146:149], v[222:225]
    ds_read_b128 v[54:57], v88 offset:20480
    s_nop 0
    v_mfma_f32_16x16x32_bf16 v[234:237], a[120:123], v[150:153], v[234:237]
    ds_read_b128 v[58:61], v87 offset:30720
    s_waitcnt lgkmcnt(11)
    v_mfma_f32_16x16x32_bf16 v[190:193], a[124:127], v[134:137], v[190:193]
    buffer_load_dwordx4 v76, s[12:15], s68 offen offset:1024 lds
    v_mfma_f32_16x16x32_bf16 v[202:205], a[124:127], v[138:141], v[202:205]
    ds_read_b128 v[62:65], v88 offset:30720
    v_readfirstlane_b32 s52, v128
    v_mfma_f32_16x16x32_bf16 v[214:217], a[124:127], v[142:145], v[214:217]
    ds_read_b128 v[66:69], v81 offset:20480
    v_mfma_f32_16x16x32_bf16 v[226:229], a[124:127], v[146:149], v[226:229]
    ds_read_b128 v[174:177], v82 offset:20480
    v_mfma_f32_16x16x32_bf16 v[238:241], a[124:127], v[150:153], v[238:241]
    ds_read_b128 v[178:181], v81 offset:30720
    s_waitcnt lgkmcnt(13)
    v_mfma_f32_16x16x32_bf16 v[194:197], v[134:137], a[128:131], v[194:197]
    buffer_load_dwordx4 v76, s[12:15], s68 offen offset:2048 lds
    v_mfma_f32_16x16x32_bf16 v[206:209], v[138:141], a[128:131], v[206:209]
    ds_read_b128 v[182:185], v82 offset:30720
    v_mfma_f32_16x16x32_bf16 v[218:221], v[142:145], a[128:131], v[218:221]
    ds_read_b128 v[154:157], v82 offset:10240
    v_mfma_f32_16x16x32_bf16 v[230:233], v[146:149], a[128:131], v[230:233]
    ds_read_b128 v[158:161], v82 offset:12288
    v_mfma_f32_16x16x32_bf16 v[242:245], v[150:153], a[128:131], v[242:245]
    ds_read_b128 v[162:165], v82 offset:14336
    s_waitcnt lgkmcnt(9)
    v_mfma_f32_16x16x32_bf16 v[102:105], v[46:49], v[50:53], v[102:105]
    s_cmp_eq_u32 s55, 3
    s_cselect_b64 exec, s[70:71], s[56:57]
    global_load_dword v17, v[70:71], off
    s_mov_b64 exec, -1
    v_mfma_f32_16x16x32_bf16 v[106:109], v[50:53], v[50:53], v[106:109]
    ds_read_b128 v[166:169], v82 offset:16384
    v_mfma_f32_16x16x32_bf16 v[102:105], v[46:49], v[54:57], v[102:105]
    ds_read_b128 v[170:173], v82 offset:18432
    v_mfma_f32_16x16x32_bf16 v[106:109], v[54:57], v[54:57], v[106:109]
    s_waitcnt lgkmcnt(9)
    v_mfma_f32_16x16x32_bf16 v[102:105], v[46:49], v[58:61], v[102:105]
    v_mfma_f32_16x16x32_bf16 v[106:109], v[58:61], v[58:61], v[106:109]
    v_mfma_f32_16x16x32_bf16 v[102:105], v[46:49], v[62:65], v[102:105]
    v_mfma_f32_16x16x32_bf16 v[106:109], v[62:65], v[62:65], v[106:109]
    s_waitcnt lgkmcnt(5)
    v_mfma_f32_16x16x32_bf16 v[116:119], v[66:69], v[66:69], v[116:119]
    v_mfma_f32_16x16x32_bf16 v[116:119], v[174:177], v[174:177], v[116:119]
    v_mfma_f32_16x16x32_bf16 v[116:119], v[178:181], v[178:181], v[116:119]
    v_mfma_f32_16x16x32_bf16 v[116:119], v[182:185], v[182:185], v[116:119]
    s_waitcnt lgkmcnt(3)
    v_mfma_f32_16x16x32_bf16 v[186:189], a[132:135], v[154:157], v[186:189]
    ds_read_b128 v[134:137], v81 offset:20480
    v_cndmask_b32 v106, v106, v107, s[46:47]
    v_mfma_f32_16x16x32_bf16 v[190:193], a[136:139], v[154:157], v[190:193]
    ds_read_b128 v[138:141], v81 offset:22528
    v_cndmask_b32 v108, v108, v109, s[46:47]
    v_mfma_f32_16x16x32_bf16 v[194:197], v[154:157], a[140:143], v[194:197]
    ds_read_b128 v[142:145], v81 offset:24576
    v_cndmask_b32 v103, v106, v108, s[48:49]
    v_mfma_f32_16x16x32_bf16 v[198:201], a[132:135], v[158:161], v[198:201]
    s_waitcnt vmcnt(8) lgkmcnt(3)
    s_barrier
    v_mfma_f32_16x16x32_bf16 v[202:205], a[136:139], v[158:161], v[202:205]
    ds_read_b64_tr_b16 a[144:145], v83 offset:0
    s_bfe_u32 s69, s96, 0x30008
    v_mfma_f32_16x16x32_bf16 v[206:209], v[158:161], a[140:143], v[206:209]
    ds_read_b64_tr_b16 a[146:147], v83 offset:512
    v_mfma_f32_16x16x32_bf16 v[210:213], a[132:135], v[162:165], v[210:213]
    ds_read_b128 v[146:149], v81 offset:26624
    s_lshl_b32 s69, s69, 16
    v_mfma_f32_16x16x32_bf16 v[214:217], a[136:139], v[162:165], v[214:217]
    ds_read_b128 v[150:153], v81 offset:28672
    s_add_u32 m0, s60, 16384
    v_mfma_f32_16x16x32_bf16 v[218:221], v[162:165], a[140:143], v[218:221]
    ds_read_b64_tr_b16 a[148:149], v83 offset:1024
    ds_read_b64_tr_b16 a[150:151], v83 offset:1536
    v_mfma_f32_16x16x32_bf16 v[222:225], a[132:135], v[166:169], v[222:225]
    ds_read_b64_tr_b16 a[152:153], v83 offset:2048
    ds_read_b64_tr_b16 a[154:155], v83 offset:2560
    v_mfma_f32_16x16x32_bf16 v[226:229], a[136:139], v[166:169], v[226:229]
    ds_read_b64_tr_b16 a[156:157], v83 offset:12288
    ds_read_b64_tr_b16 a[158:159], v83 offset:12800
    v_mfma_f32_16x16x32_bf16 v[230:233], v[166:169], a[140:143], v[230:233]
    ds_read_b64_tr_b16 a[160:161], v83 offset:13312
    ds_read_b64_tr_b16 a[162:163], v83 offset:13824
    v_mfma_f32_16x16x32_bf16 v[234:237], a[132:135], v[170:173], v[234:237]
    ds_read_b64_tr_b16 a[164:165], v83 offset:14336
    ds_read_b64_tr_b16 a[166:167], v83 offset:14848
    v_mfma_f32_16x16x32_bf16 v[238:241], a[136:139], v[170:173], v[238:241]
    v_mov_b32 v112, v116
    v_mov_b32 v114, v116
    v_mfma_f32_16x16x32_bf16 v[242:245], v[170:173], a[140:143], v[242:245]
    v_cndmask_b32 v116, v116, v117, s[46:47]
    s_waitcnt lgkmcnt(10)
    v_mfma_f32_16x16x32_bf16 v[186:189], a[144:147], v[134:137], v[186:189]
    ds_read_b128 v[154:157], v82 offset:20480
    v_cndmask_b32 v118, v118, v119, s[46:47]
    v_mfma_f32_16x16x32_bf16 v[198:201], a[144:147], v[138:141], v[198:201]
    ds_read_b128 v[158:161], v82 offset:22528
    v_cndmask_b32 v113, v116, v118, s[48:49]
    v_mfma_f32_16x16x32_bf16 v[210:213], a[144:147], v[142:145], v[210:213]
    ds_read_b128 v[162:165], v82 offset:24576
    v_permlane16_swap_b32 v112, v114
    v_mfma_f32_16x16x32_bf16 v[222:225], a[144:147], v[146:149], v[222:225]
    ds_read_b128 v[166:169], v82 offset:26624
    v_mov_b32 v114, v112
    v_mfma_f32_16x16x32_bf16 v[234:237], a[144:147], v[150:153], v[234:237]
    ds_read_b128 v[170:173], v82 offset:28672
    s_waitcnt lgkmcnt(13)
    v_mfma_f32_16x16x32_bf16 v[190:193], a[148:151], v[134:137], v[190:193]
    v_mul_f32 v246, 0xbb000000, v102
    v_mul_f32 v248, 0x3b000000, v103
    v_mfma_f32_16x16x32_bf16 v[202:205], a[148:151], v[138:141], v[202:205]
    v_fma_f32 v248, -v246, v246, v248
    v_max_f32 v248, 0, v248
    v_mfma_f32_16x16x32_bf16 v[214:217], a[148:151], v[142:145], v[214:217]
    v_add_f32 v247, 0x3727c5ac, v248
    v_rsq_f32 v247, v247
    v_mfma_f32_16x16x32_bf16 v[226:229], a[148:151], v[146:149], v[226:229]
    v_permlane32_swap_b32 v112, v114
    v_mul_f32 v250, 0xbb000000, v112
    v_mfma_f32_16x16x32_bf16 v[238:241], a[148:151], v[150:153], v[238:241]
    v_mul_f32 v248, 0x3b000000, v113
    s_waitcnt lgkmcnt(11)
    v_mfma_f32_16x16x32_bf16 v[194:197], v[134:137], a[152:155], v[194:197]
    v_fma_f32 v248, -v250, v250, v248
    v_max_f32 v248, 0, v248
    v_mfma_f32_16x16x32_bf16 v[206:209], v[138:141], a[152:155], v[206:209]
    v_add_f32 v251, 0x3727c5ac, v248
    v_rsq_f32 v251, v251
    ds_read_b64 v[52:53], v93 offset:0
    ds_read_b64 v[56:57], v93 offset:2048
    ds_read_b64 v[60:61], v93 offset:4096
    ds_read_b64 v[64:65], v93 offset:6144
    ds_read_b64 v[68:69], v93 offset:8192
    s_waitcnt vmcnt(1)
    s_mov_b64 exec, s[44:45]
    ds_write_b64 v98, v[246:247] offset:256
    ds_write2_b32 v99, v246, v247 offset0:0 offset1:80
    ds_write_b64 v12, v[250:251]
    ds_write2_b32 v101, v250, v251 offset0:0 offset1:80
    s_mov_b64 exec, -1
    v_mfma_f32_16x16x32_bf16 v[218:221], v[142:145], a[152:155], v[218:221]
    buffer_load_dwordx4 v77, s[16:19], s69 offen lds
    v_mfma_f32_16x16x32_bf16 v[230:233], v[146:149], a[152:155], v[230:233]
    v_mfma_f32_16x16x32_bf16 v[242:245], v[150:153], a[152:155], v[242:245]
    s_waitcnt lgkmcnt(12)
    v_mfma_f32_16x16x32_bf16 v[186:189], a[156:159], v[154:157], v[186:189]
    ds_read_b128 v[134:137], v81 offset:30720
    v_mfma_f32_16x16x32_bf16 v[190:193], a[160:163], v[154:157], v[190:193]
    buffer_load_dwordx4 v78, s[16:19], s69 offen offset:1024 lds
    v_mfma_f32_16x16x32_bf16 v[194:197], v[154:157], a[164:167], v[194:197]
    ds_read_b128 v[138:141], v81 offset:32768
    s_bfe_u32 s69, s96, 0x3000c
    v_mfma_f32_16x16x32_bf16 v[198:201], a[156:159], v[158:161], v[198:201]
    s_lshl_b32 s69, s69, 16
    s_add_u32 m0, s60, 24576
    s_waitcnt lgkmcnt(2)
    s_barrier
    v_mfma_f32_16x16x32_bf16 v[202:205], a[160:163], v[158:161], v[202:205]
    buffer_load_dwordx4 v77, s[16:19], s69 offen lds
    v_mfma_f32_16x16x32_bf16 v[206:209], v[158:161], a[164:167], v[206:209]
    ds_read_b64_tr_b16 a[168:169], v83 offset:24576
    v_mfma_f32_16x16x32_bf16 v[210:213], a[156:159], v[162:165], v[210:213]
    ds_read_b64_tr_b16 a[170:171], v83 offset:25088
    ds_read_b128 v[142:145], v81 offset:34816
    v_mfma_f32_16x16x32_bf16 v[214:217], a[160:163], v[162:165], v[214:217]
    ds_read_b128 v[146:149], v81 offset:36864
    v_mfma_f32_16x16x32_bf16 v[218:221], v[162:165], a[164:167], v[218:221]
    buffer_load_dwordx4 v78, s[16:19], s69 offen offset:1024 lds
    v_mfma_f32_16x16x32_bf16 v[222:225], a[156:159], v[166:169], v[222:225]
    ds_read_b128 v[150:153], v81 offset:38912
    s_bfe_u32 s69, s96, 0x30010
    v_mfma_f32_16x16x32_bf16 v[226:229], a[160:163], v[166:169], v[226:229]
    ds_read_b64_tr_b16 a[172:173], v83 offset:25600
    s_lshl_b32 s69, s69, 16
    v_mfma_f32_16x16x32_bf16 v[230:233], v[166:169], a[164:167], v[230:233]
    ds_read_b64_tr_b16 a[174:175], v83 offset:26112
    s_add_u32 m0, s60, 32768
    v_mfma_f32_16x16x32_bf16 v[234:237], a[156:159], v[170:173], v[234:237]
    buffer_load_dwordx4 v77, s[16:19], s69 offen lds
    v_mfma_f32_16x16x32_bf16 v[238:241], a[160:163], v[170:173], v[238:241]
    ds_read_b64_tr_b16 a[176:177], v83 offset:26624
    ds_read_b64_tr_b16 a[178:179], v83 offset:27136
    v_mfma_f32_16x16x32_bf16 v[242:245], v[170:173], a[164:167], v[242:245]
    ds_read_b64_tr_b16 a[180:181], v83 offset:36864
    s_waitcnt lgkmcnt(5)
    v_mfma_f32_16x16x32_bf16 v[186:189], a[168:171], v[134:137], v[186:189]
    ds_read_b64_tr_b16 a[182:183], v83 offset:37376
    ds_read_b64_tr_b16 a[184:185], v83 offset:37888
    v_mfma_f32_16x16x32_bf16 v[198:201], a[168:171], v[138:141], v[198:201]
    buffer_load_dwordx4 v78, s[16:19], s69 offen offset:1024 lds
    v_mfma_f32_16x16x32_bf16 v[210:213], a[168:171], v[142:145], v[210:213]
    ds_read_b64_tr_b16 a[186:187], v83 offset:38400
    s_bfe_u32 s69, s96, 0x30014
    v_mfma_f32_16x16x32_bf16 v[222:225], a[168:171], v[146:149], v[222:225]
    ds_read_b64_tr_b16 a[188:189], v83 offset:38912
    s_lshl_b32 s69, s69, 16
    v_mfma_f32_16x16x32_bf16 v[234:237], a[168:171], v[150:153], v[234:237]
    ds_read_b64_tr_b16 a[190:191], v83 offset:39424
    s_waitcnt lgkmcnt(8)
    v_mfma_f32_16x16x32_bf16 v[190:193], a[172:175], v[134:137], v[190:193]
    ds_read_b128 v[154:157], v82 offset:30720
    s_add_u32 m0, s60, 40960
    v_mfma_f32_16x16x32_bf16 v[202:205], a[172:175], v[138:141], v[202:205]
    buffer_load_dwordx4 v77, s[16:19], s69 offen lds
    v_mfma_f32_16x16x32_bf16 v[214:217], a[172:175], v[142:145], v[214:217]
    ds_read_b128 v[158:161], v82 offset:32768
    v_mfma_f32_16x16x32_bf16 v[226:229], a[172:175], v[146:149], v[226:229]
    ds_read_b128 v[162:165], v82 offset:34816
    v_mfma_f32_16x16x32_bf16 v[238:241], a[172:175], v[150:153], v[238:241]
    ds_read_b128 v[166:169], v82 offset:36864
    s_waitcnt lgkmcnt(10)
    v_mfma_f32_16x16x32_bf16 v[194:197], v[134:137], a[176:179], v[194:197]
    buffer_load_dwordx4 v78, s[16:19], s69 offen offset:1024 lds
    v_mfma_f32_16x16x32_bf16 v[206:209], v[138:141], a[176:179], v[206:209]
    ds_read_b128 v[170:173], v82 offset:38912
    s_bfe_u32 s69, s96, 0x30018
    v_mfma_f32_16x16x32_bf16 v[218:221], v[142:145], a[176:179], v[218:221]
    s_lshl_b32 s69, s69, 16
    s_add_u32 m0, s60, 49152
    v_mfma_f32_16x16x32_bf16 v[230:233], v[146:149], a[176:179], v[230:233]
    v_mfma_f32_16x16x32_bf16 v[242:245], v[150:153], a[176:179], v[242:245]
    s_waitcnt lgkmcnt(3)
    v_mfma_f32_16x16x32_bf16 v[186:189], a[180:183], v[154:157], v[186:189]
    buffer_load_dwordx4 v77, s[16:19], s69 offen lds
    v_mfma_f32_16x16x32_bf16 v[190:193], a[184:187], v[154:157], v[190:193]
    ds_read_b64 v[174:175], v12 offset:0
    ds_read_b64 v[176:177], v12 offset:256
    v_mfma_f32_16x16x32_bf16 v[194:197], v[154:157], a[188:191], v[194:197]
    ds_read_b64 v[178:179], v12 offset:512
    ds_read_b64 v[180:181], v12 offset:768
    v_mfma_f32_16x16x32_bf16 v[198:201], a[180:183], v[158:161], v[198:201]
    ds_read_b64 v[182:183], v12 offset:1024
    ds_read_b128 v[134:137], v13 offset:0
    v_mfma_f32_16x16x32_bf16 v[202:205], a[184:187], v[158:161], v[202:205]
    buffer_load_dwordx4 v78, s[16:19], s69 offen offset:1024 lds
    v_mfma_f32_16x16x32_bf16 v[206:209], v[158:161], a[188:191], v[206:209]
    ds_read_b128 v[138:141], v13 offset:320
    s_waitcnt lgkmcnt(7)
    v_mfma_f32_16x16x32_bf16 v[210:213], a[180:183], v[162:165], v[210:213]
    ds_read_b128 v[142:145], v13 offset:64
    s_bfe_u32 s69, s96, 0x30000
    v_mfma_f32_16x16x32_bf16 v[214:217], a[184:187], v[162:165], v[214:217]
    ds_read_b128 v[146:149], v13 offset:384
    s_lshl_b32 s69, s69, 16
    v_mfma_f32_16x16x32_bf16 v[218:221], v[162:165], a[188:191], v[218:221]
    s_add_u32 m0, s60, 0
    v_mov_b32_dpp v28, v186 row_newbcast:0 row_mask:0xf bank_mask:0xf
    v_mfma_f32_16x16x32_bf16 v[222:225], a[180:183], v[166:169], v[222:225]
    buffer_load_dwordx4 v77, s[16:19], s69 offen lds
    v_mfma_f32_16x16x32_bf16 v[226:229], a[184:187], v[166:169], v[226:229]
    v_mov_b32_dpp v32, v190 row_newbcast:0 row_mask:0xf bank_mask:0xf
    v_mov_b32_dpp v29, v187 row_newbcast:0 row_mask:0xf bank_mask:0xf
    v_mfma_f32_16x16x32_bf16 v[230:233], v[166:169], a[188:191], v[230:233]
    v_mov_b32_dpp v33, v191 row_newbcast:0 row_mask:0xf bank_mask:0xf
    v_mov_b32_dpp v30, v188 row_newbcast:0 row_mask:0xf bank_mask:0xf
    v_mfma_f32_16x16x32_bf16 v[234:237], a[180:183], v[170:173], v[234:237]
    v_mov_b32_dpp v34, v192 row_newbcast:0 row_mask:0xf bank_mask:0xf
    v_mov_b32_dpp v31, v189 row_newbcast:0 row_mask:0xf bank_mask:0xf
    v_mfma_f32_16x16x32_bf16 v[238:241], a[184:187], v[170:173], v[238:241]
    buffer_load_dwordx4 v78, s[16:19], s69 offen offset:1024 lds
    v_mfma_f32_16x16x32_bf16 v[242:245], v[170:173], a[188:191], v[242:245]
    s_bfe_u32 s69, s96, 0x30004
    s_lshl_b32 s69, s69, 16
    v_mov_b32_dpp v35, v193 row_newbcast:0 row_mask:0xf bank_mask:0xf
    v_mov_b32 v36, v194
    v_mov_b32 v37, v194
    s_nop 1
    v_permlane16_swap_b32 v36, v37
    ds_read_b128 v[154:157], v13 offset:128
    ds_read_b128 v[158:161], v13 offset:448
    ds_read_b128 v[162:165], v13 offset:192
    ds_read_b128 v[166:169], v13 offset:512
    v_mov_b32 v37, v36
    s_nop 1
    v_permlane32_swap_b32 v36, v37
    v_mov_b32 v246, 0xf149f2ca
    v_cndmask_b32 v250, v24, v246, s[50:51]
    v_cndmask_b32 v251, v25, v246, s[50:51]
    v_cndmask_b32 v252, v26, v246, s[50:51]
    v_cndmask_b32 v253, v27, v246, s[50:51]
    s_waitcnt lgkmcnt(6)
    v_pk_fma_f32 v[186:187], v[28:29], v[174:175], v[186:187] op_sel_hi:[1,0,1]
    v_pk_fma_f32 v[190:191], v[32:33], v[174:175], v[190:191] op_sel_hi:[1,0,1]
    v_pk_fma_f32 v[194:195], v[36:37], v[134:135], v[194:195] op_sel_hi:[0,1,1]
    s_add_u32 m0, s60, 8192
    s_nop 0
    buffer_load_dwordx4 v77, s[16:19], s69 offen lds
    v_pk_fma_f32 v[188:189], v[30:31], v[174:175], v[188:189] op_sel_hi:[1,0,1]
    v_pk_fma_f32 v[192:193], v[34:35], v[174:175], v[192:193] op_sel_hi:[1,0,1]
    v_pk_fma_f32 v[196:197], v[36:37], v[136:137], v[196:197] op_sel_hi:[0,1,1]
    v_pk_mul_f32 v[190:191], v[190:191], v[174:175] op_sel:[0,1] op_sel_hi:[1,1]
    v_pk_mul_f32 v[194:195], v[194:195], v[138:139]
    v_pk_mul_f32 v[192:193], v[192:193], v[174:175] op_sel:[0,1] op_sel_hi:[1,1]
    v_pk_mul_f32 v[196:197], v[196:197], v[140:141]
    ds_read_b128 v[134:137], v13 offset:256
    ds_read_b128 v[138:141], v13 offset:576
    v_cvt_pk_bf16_f32 v102, v186, v187
    v_cvt_pk_bf16_f32 v103, v188, v189
    v_cvt_pk_bf16_f32 v112, v190, v191
    v_cvt_pk_bf16_f32 v113, v192, v193
    v_cvt_pk_bf16_f32 v124, v194, v195
    v_cvt_pk_bf16_f32 v125, v196, v197
    v_mul_f32 v175, 0x3eb8aa3b, v175
    s_waitcnt lgkmcnt(6)
    v_pk_fma_f32 v[198:199], v[28:29], v[176:177], v[198:199] op_sel_hi:[1,0,1]
    v_pk_fma_f32 v[202:203], v[32:33], v[176:177], v[202:203] op_sel_hi:[1,0,1]
    buffer_load_dwordx4 v78, s[16:19], s69 offen offset:1024 lds
    v_pk_fma_f32 v[206:207], v[36:37], v[142:143], v[206:207] op_sel_hi:[0,1,1]
    v_pk_fma_f32 v[200:201], v[30:31], v[176:177], v[200:201] op_sel_hi:[1,0,1]
    v_pk_fma_f32 v[204:205], v[34:35], v[176:177], v[204:205] op_sel_hi:[1,0,1]
    v_pk_fma_f32 v[208:209], v[36:37], v[144:145], v[208:209] op_sel_hi:[0,1,1]
    v_pk_mul_f32 v[202:203], v[202:203], v[176:177] op_sel:[0,1] op_sel_hi:[1,1]
    v_pk_mul_f32 v[206:207], v[206:207], v[146:147]
    v_pk_mul_f32 v[204:205], v[204:205], v[176:177] op_sel:[0,1] op_sel_hi:[1,1]
    v_pk_mul_f32 v[208:209], v[208:209], v[148:149]
    v_mfma_f32_16x16x16_bf16 v[186:189], v[112:113], v[102:103], v[20:23]
    v_cvt_pk_bf16_f32 v104, v198, v199
    v_cvt_pk_bf16_f32 v105, v200, v201
    v_cvt_pk_bf16_f32 v114, v202, v203
    v_cvt_pk_bf16_f32 v115, v204, v205
    v_cvt_pk_bf16_f32 v126, v206, v207
    v_cvt_pk_bf16_f32 v127, v208, v209
    v_mul_f32 v177, 0x3eb8aa3b, v177
    s_waitcnt lgkmcnt(4)
    v_pk_fma_f32 v[210:211], v[28:29], v[178:179], v[210:211] op_sel_hi:[1,0,1]
    s_bfe_u32 s69, s96, 0x3001c
    s_lshl_b32 s69, s69, 16
    s_add_u32 m0, s60, 57344
    s_nop 0
    buffer_load_dwordx4 v77, s[16:19], s69 offen lds
    v_pk_fma_f32 v[214:215], v[32:33], v[178:179], v[214:215] op_sel_hi:[1,0,1]
    v_pk_fma_f32 v[218:219], v[36:37], v[154:155], v[218:219] op_sel_hi:[0,1,1]
    v_pk_fma_f32 v[212:213], v[30:31], v[178:179], v[212:213] op_sel_hi:[1,0,1]
    v_pk_fma_f32 v[216:217], v[34:35], v[178:179], v[216:217] op_sel_hi:[1,0,1]
    v_pk_fma_f32 v[220:221], v[36:37], v[156:157], v[220:221] op_sel_hi:[0,1,1]
    v_pk_mul_f32 v[214:215], v[214:215], v[178:179] op_sel:[0,1] op_sel_hi:[1,1]
    v_pk_mul_f32 v[218:219], v[218:219], v[158:159]
    v_pk_mul_f32 v[216:217], v[216:217], v[178:179] op_sel:[0,1] op_sel_hi:[1,1]
    v_pk_mul_f32 v[220:221], v[220:221], v[160:161]
    v_mfma_f32_16x16x16_bf16 v[198:201], v[114:115], v[104:105], v[20:23]
    v_cvt_pk_bf16_f32 v106, v210, v211
    v_cvt_pk_bf16_f32 v107, v212, v213
    v_mfma_f32_16x16x16_bf16 v[202:205], v[112:113], v[104:105], v[250:253]
    v_cvt_pk_bf16_f32 v116, v214, v215
    v_cvt_pk_bf16_f32 v117, v216, v217
    v_cvt_pk_bf16_f32 v128, v218, v219
    v_cvt_pk_bf16_f32 v129, v220, v221
    v_mul_f32 v179, 0x3eb8aa3b, v179
    buffer_load_dwordx4 v78, s[16:19], s69 offen offset:1024 lds
    s_waitcnt lgkmcnt(2)
    v_pk_fma_f32 v[222:223], v[28:29], v[180:181], v[222:223] op_sel_hi:[1,0,1]
    v_pk_fma_f32 v[226:227], v[32:33], v[180:181], v[226:227] op_sel_hi:[1,0,1]
    v_pk_fma_f32 v[230:231], v[36:37], v[162:163], v[230:231] op_sel_hi:[0,1,1]
    v_pk_fma_f32 v[224:225], v[30:31], v[180:181], v[224:225] op_sel_hi:[1,0,1]
    v_pk_fma_f32 v[228:229], v[34:35], v[180:181], v[228:229] op_sel_hi:[1,0,1]
    v_pk_fma_f32 v[232:233], v[36:37], v[164:165], v[232:233] op_sel_hi:[0,1,1]
    v_pk_mul_f32 v[226:227], v[226:227], v[180:181] op_sel:[0,1] op_sel_hi:[1,1]
    v_pk_mul_f32 v[230:231], v[230:231], v[166:167]
    v_pk_mul_f32 v[228:229], v[228:229], v[180:181] op_sel:[0,1] op_sel_hi:[1,1]
    v_pk_mul_f32 v[232:233], v[232:233], v[168:169]
    v_mfma_f32_16x16x16_bf16 v[210:213], v[116:117], v[106:107], v[20:23]
    v_cvt_pk_bf16_f32 v108, v222, v223
    v_cvt_pk_bf16_f32 v109, v224, v225
    v_mfma_f32_16x16x16_bf16 v[214:217], v[114:115], v[106:107], v[24:27]
    v_cvt_pk_bf16_f32 v118, v226, v227
    v_cvt_pk_bf16_f32 v119, v228, v229
    v_cvt_pk_bf16_f32 v130, v230, v231
    v_cvt_pk_bf16_f32 v131, v232, v233
    s_mov_b32 s0, 65536
    s_mov_b64 exec, 0xfffff
    buffer_load_dword v17, v90, s[20:23], s0 offen
    s_mov_b64 exec, -1
    v_mul_f32 v181, 0x3eb8aa3b, v181
    s_waitcnt lgkmcnt(0)
    v_pk_fma_f32 v[234:235], v[28:29], v[182:183], v[234:235] op_sel_hi:[1,0,1]
    v_pk_fma_f32 v[238:239], v[32:33], v[182:183], v[238:239] op_sel_hi:[1,0,1]
    v_pk_fma_f32 v[242:243], v[36:37], v[134:135], v[242:243] op_sel_hi:[0,1,1]
    v_pk_fma_f32 v[236:237], v[30:31], v[182:183], v[236:237] op_sel_hi:[1,0,1]
    v_pk_fma_f32 v[240:241], v[34:35], v[182:183], v[240:241] op_sel_hi:[1,0,1]
    v_pk_fma_f32 v[244:245], v[36:37], v[136:137], v[244:245] op_sel_hi:[0,1,1]
    v_pk_mul_f32 v[238:239], v[238:239], v[182:183] op_sel:[0,1] op_sel_hi:[1,1]
    v_pk_mul_f32 v[242:243], v[242:243], v[138:139]
    v_pk_mul_f32 v[240:241], v[240:241], v[182:183] op_sel:[0,1] op_sel_hi:[1,1]
    v_pk_mul_f32 v[244:245], v[244:245], v[140:141]
    v_mfma_f32_16x16x16_bf16 v[222:225], v[118:119], v[108:109], v[20:23]
    v_cvt_pk_bf16_f32 v110, v234, v235
    v_cvt_pk_bf16_f32 v111, v236, v237
    v_mfma_f32_16x16x16_bf16 v[226:229], v[116:117], v[108:109], v[24:27]
    v_cvt_pk_bf16_f32 v120, v238, v239
    v_cvt_pk_bf16_f32 v121, v240, v241
    v_cvt_pk_bf16_f32 v132, v242, v243
    s_mov_b32 s0, 2686976
    s_mov_b64 exec, 0xfffff
    buffer_load_dword v17, v90, s[20:23], s0 offen
    s_mov_b64 exec, -1
    v_cvt_pk_bf16_f32 v133, v244, v245
    v_mul_f32 v183, 0x3eb8aa3b, v183
    v_mfma_f32_16x16x16_bf16 v[234:237], v[120:121], v[110:111], v[20:23]
    v_mfma_f32_16x16x16_bf16 v[238:241], v[118:119], v[110:111], v[24:27]
    v_max3_f32 v134, v186, v187, v188
    v_max_f32 v134, v134, v189
    v_mov_b32 v140, v134
    v_max_f32 v198, v198, v202
    v_max_f32 v199, v199, v203
    v_max_f32 v200, v200, v204
    v_max_f32 v201, v201, v205
    v_max3_f32 v135, v198, v199, v200
    v_max_f32 v135, v135, v201
    v_mov_b32 v141, v135
    v_max_f32 v210, v210, v214
    v_max_f32 v211, v211, v215
    v_max_f32 v212, v212, v216
    v_max_f32 v213, v213, v217
    s_mov_b64 exec, 0xff
    buffer_load_dword v17, v91, s[20:23], 0 offen
    s_mov_b64 exec, -1
    v_max3_f32 v136, v210, v211, v212
    v_max_f32 v136, v136, v213
    v_mov_b32 v142, v136
    v_max_f32 v222, v222, v226
    v_max_f32 v223, v223, v227
    v_max_f32 v224, v224, v228
    v_max_f32 v225, v225, v229
    v_max3_f32 v137, v222, v223, v224
    v_max_f32 v137, v137, v225
    v_mov_b32 v143, v137
    v_max_f32 v234, v234, v238
    v_max_f32 v235, v235, v239
    v_max_f32 v236, v236, v240
    v_max_f32 v237, v237, v241
    v_max3_f32 v138, v234, v235, v236
    v_max_f32 v138, v138, v237
    global_load_dword v16, v254, s[40:41] sc1
    v_mov_b32 v144, v138
    v_permlane32_swap_b32 v134, v140
    v_permlane32_swap_b32 v135, v141
    v_permlane32_swap_b32 v136, v142
    v_permlane32_swap_b32 v137, v143
    v_permlane32_swap_b32 v138, v144
    v_max_f32 v134, v134, v140
    v_mov_b32 v140, v134
    v_max_f32 v135, v135, v141
    v_mov_b32 v141, v135
    v_max_f32 v136, v136, v142
    v_mov_b32 v142, v136
    v_max_f32 v137, v137, v143
    v_mov_b32 v143, v137
    v_max_f32 v138, v138, v144
    v_mov_b32 v144, v138
    v_permlane16_swap_b32 v134, v140
    v_permlane16_swap_b32 v135, v141
    v_permlane16_swap_b32 v136, v142
    v_permlane16_swap_b32 v137, v143
    v_permlane16_swap_b32 v138, v144
    v_max_f32 v134, v134, v140
    v_mul_f32 v134, v134, v175
    v_pk_fma_f32 v[186:187], v[186:187], v[174:175], v[134:135] op_sel:[0,1,0] op_sel_hi:[1,1,0] neg_lo:[0,0,1] neg_hi:[0,0,1]
    v_pk_fma_f32 v[188:189], v[188:189], v[174:175], v[134:135] op_sel:[0,1,0] op_sel_hi:[1,1,0] neg_lo:[0,0,1] neg_hi:[0,0,1]
    v_max_f32 v135, v135, v141
    v_mul_f32 v135, v135, v177
    v_pk_fma_f32 v[198:199], v[198:199], v[176:177], v[134:135] op_sel:[0,1,1] op_sel_hi:[1,1,1] neg_lo:[0,0,1] neg_hi:[0,0,1]
    v_pk_fma_f32 v[200:201], v[200:201], v[176:177], v[134:135] op_sel:[0,1,1] op_sel_hi:[1,1,1] neg_lo:[0,0,1] neg_hi:[0,0,1]
    v_max_f32 v136, v136, v142
    v_mul_f32 v136, v136, v179
    v_pk_fma_f32 v[210:211], v[210:211], v[178:179], v[136:137] op_sel:[0,1,0] op_sel_hi:[1,1,0] neg_lo:[0,0,1] neg_hi:[0,0,1]
    v_pk_fma_f32 v[212:213], v[212:213], v[178:179], v[136:137] op_sel:[0,1,0] op_sel_hi:[1,1,0] neg_lo:[0,0,1] neg_hi:[0,0,1]
    v_max_f32 v137, v137, v143
    v_mul_f32 v137, v137, v181
    v_pk_fma_f32 v[222:223], v[222:223], v[180:181], v[136:137] op_sel:[0,1,1] op_sel_hi:[1,1,1] neg_lo:[0,0,1] neg_hi:[0,0,1]
    v_pk_fma_f32 v[224:225], v[224:225], v[180:181], v[136:137] op_sel:[0,1,1] op_sel_hi:[1,1,1] neg_lo:[0,0,1] neg_hi:[0,0,1]
    v_max_f32 v138, v138, v144
    v_mul_f32 v138, v138, v183
    v_pk_fma_f32 v[234:235], v[234:235], v[182:183], v[138:139] op_sel:[0,1,0] op_sel_hi:[1,1,0] neg_lo:[0,0,1] neg_hi:[0,0,1]
    v_pk_fma_f32 v[236:237], v[236:237], v[182:183], v[138:139] op_sel:[0,1,0] op_sel_hi:[1,1,0] neg_lo:[0,0,1] neg_hi:[0,0,1]
    v_exp_f32 v186, v186
    v_exp_f32 v187, v187
    v_exp_f32 v188, v188
    v_exp_f32 v189, v189
    v_cvt_pk_bf16_f32 v166, v186, v187
    v_cvt_pk_bf16_f32 v167, v188, v189
    v_bfi_b32 v146, v18, 0, v166
    v_and_b32 v148, v18, v166
    v_bfi_b32 v147, v19, 0, v167
    v_and_b32 v149, v19, v167
    v_mfma_f32_16x16x16_bf16 v[190:193], v[46:47], v[166:167], 0
    v_exp_f32 v198, v198
    v_mfma_f32_16x16x32_bf16 v[186:189], v[122:125], v[146:149], 0
    v_exp_f32 v199, v199
    v_exp_f32 v200, v200
    v_exp_f32 v201, v201
    v_cvt_pk_bf16_f32 v168, v198, v199
    v_cvt_pk_bf16_f32 v169, v200, v201
    v_bfi_b32 v150, v18, 0, v168
    v_and_b32 v152, v18, v168
    v_bfi_b32 v151, v19, 0, v169
    v_and_b32 v153, v19, v169
    v_mfma_f32_16x16x16_bf16 v[202:205], v[46:47], v[168:169], 0
    v_exp_f32 v210, v210
    v_mfma_f32_16x16x32_bf16 v[198:201], v[124:127], v[150:153], 0
    v_exp_f32 v211, v211
    v_exp_f32 v212, v212
    v_exp_f32 v213, v213
    v_cvt_pk_bf16_f32 v170, v210, v211
    v_cvt_pk_bf16_f32 v171, v212, v213
    v_bfi_b32 v154, v18, 0, v170
    v_and_b32 v156, v18, v170
    v_bfi_b32 v155, v19, 0, v171
    v_and_b32 v157, v19, v171
    v_mfma_f32_16x16x16_bf16 v[214:217], v[46:47], v[170:171], 0
    v_exp_f32 v222, v222
    v_mfma_f32_16x16x32_bf16 v[210:213], v[126:129], v[154:157], 0
    v_exp_f32 v223, v223
    v_exp_f32 v224, v224
    v_exp_f32 v225, v225
    v_cvt_pk_bf16_f32 v172, v222, v223
    v_cvt_pk_bf16_f32 v173, v224, v225
    v_bfi_b32 v158, v18, 0, v172
    v_and_b32 v160, v18, v172
    v_bfi_b32 v159, v19, 0, v173
    v_and_b32 v161, v19, v173
    v_mfma_f32_16x16x16_bf16 v[226:229], v[46:47], v[172:173], 0
    v_exp_f32 v234, v234
    v_mfma_f32_16x16x32_bf16 v[222:225], v[128:131], v[158:161], 0
    v_exp_f32 v235, v235
    v_exp_f32 v236, v236
    v_exp_f32 v237, v237
    v_cvt_pk_bf16_f32 v184, v234, v235
    v_cvt_pk_bf16_f32 v185, v236, v237
    v_bfi_b32 v162, v18, 0, v184
    v_and_b32 v164, v18, v184
    v_bfi_b32 v163, v19, 0, v185
    v_and_b32 v165, v19, v185
    v_mfma_f32_16x16x16_bf16 v[238:241], v[46:47], v[184:185], 0
    s_nop 0
    v_mfma_f32_16x16x32_bf16 v[234:237], v[130:133], v[162:165], 0
    v_rcp_f32 v190, v190
    v_rcp_f32 v202, v202
    v_rcp_f32 v214, v214
    v_rcp_f32 v226, v226
    s_nop 1
    v_rcp_f32 v238, v238
    v_pk_mul_f32 v[186:187], v[186:187], v[190:191] op_sel_hi:[1,0]
    v_pk_mul_f32 v[188:189], v[188:189], v[190:191] op_sel_hi:[1,0]
    v_cvt_pk_bf16_f32 v110, v186, v187
    v_cvt_pk_bf16_f32 v111, v188, v189
    v_pk_mul_f32 v[198:199], v[198:199], v[202:203] op_sel_hi:[1,0]
    v_pk_mul_f32 v[200:201], v[200:201], v[202:203] op_sel_hi:[1,0]
    v_cvt_pk_bf16_f32 v102, v198, v199
    v_cvt_pk_bf16_f32 v103, v200, v201
    v_pk_mul_f32 v[210:211], v[210:211], v[214:215] op_sel_hi:[1,0]
    v_pk_mul_f32 v[212:213], v[212:213], v[214:215] op_sel_hi:[1,0]
    v_cvt_pk_bf16_f32 v104, v210, v211
    v_cvt_pk_bf16_f32 v105, v212, v213
    v_pk_mul_f32 v[222:223], v[222:223], v[226:227] op_sel_hi:[1,0]
    v_pk_mul_f32 v[224:225], v[224:225], v[226:227] op_sel_hi:[1,0]
    v_cvt_pk_bf16_f32 v106, v222, v223
    v_cvt_pk_bf16_f32 v107, v224, v225
    v_pk_mul_f32 v[234:235], v[234:235], v[238:239] op_sel_hi:[1,0]
    v_pk_mul_f32 v[236:237], v[236:237], v[238:239] op_sel_hi:[1,0]
    v_cvt_pk_bf16_f32 v108, v234, v235
    v_cvt_pk_bf16_f32 v109, v236, v237
    v_permlane16_swap_b32 v102, v104
    v_permlane16_swap_b32 v103, v105
    v_permlane16_swap_b32 v106, v108
    v_permlane16_swap_b32 v107, v109
    v_permlane16_swap_b32 v110, v112
    v_permlane16_swap_b32 v111, v113
    s_mov_b32 s0, 81920
    buffer_store_dwordx4 v[102:105], v10, s[20:23], s0 offen
    ds_write_b128 v11, v[102:105] offset:2048
    s_mov_b32 s0, 114688
    buffer_store_dwordx4 v[106:109], v10, s[20:23], s0 offen
    ds_write_b128 v11, v[106:109] offset:6144
    s_mov_b32 exec_lo, 0xffff
    s_mov_b32 exec_hi, 0xffff
    s_mov_b32 s0, 65536
    buffer_store_dwordx4 v[110:113], v10, s[20:23], s0 offen
    ds_write_b128 v11, v[110:113] offset:0
    s_mov_b64 exec, -1
    s_lshl_b32 s0, s4, 2
    s_add_u32 s0, s0, s3
    s_lshl_b64 s[70:71], 1, s0
    v_mov_b32 v246, s53
    v_lshlrev_b32 v50, 16, v52
    v_and_b32 v51, 0xffff0000, v52
    v_lshlrev_b32 v52, 16, v53
    v_and_b32 v53, 0xffff0000, v53
    v_lshlrev_b32 v54, 16, v56
    v_and_b32 v55, 0xffff0000, v56
    v_lshlrev_b32 v56, 16, v57
    v_and_b32 v57, 0xffff0000, v57
    v_lshlrev_b32 v58, 16, v60
    v_and_b32 v59, 0xffff0000, v60
    v_lshlrev_b32 v60, 16, v61
    v_and_b32 v61, 0xffff0000, v61
    v_lshlrev_b32 v62, 16, v64
    v_and_b32 v63, 0xffff0000, v64
    v_lshlrev_b32 v64, 16, v65
    v_and_b32 v65, 0xffff0000, v65
    v_lshlrev_b32 v66, 16, v68
    v_and_b32 v67, 0xffff0000, v68
    v_lshlrev_b32 v68, 16, v69
    v_and_b32 v69, 0xffff0000, v69
    s_mul_i32 s58, s3, 3584
    s_mov_b32 s6, 0
    s_lshl_b32 s63, s3, 13
    s_max_i32 s67, s7, 0
    s_waitcnt vmcnt(0) lgkmcnt(0)
    v_cmp_eq_u32 vcc, 0, v16
    s_nop 0
    s_andn2_b64 vcc, vcc, s[46:47]
    s_cbranch_vccnz L_gow_2
L_gob_3:
    s_mov_b64 exec, s[70:71]
    buffer_store_dword v246, v15, s[20:23], 0 offen offset:0
    s_mov_b64 exec, -1
    s_barrier
    ds_read_b64_tr_b16 a[192:193], v84 offset:0
    ds_read_b64_tr_b16 a[194:195], v84 offset:512
    ds_read_b64_tr_b16 a[196:197], v84 offset:4096
    ds_read_b64_tr_b16 a[198:199], v84 offset:4608
    ds_read_b64_tr_b16 a[200:201], v84 offset:8192
    ds_read_b64_tr_b16 a[202:203], v84 offset:8704
    ds_read_b64_tr_b16 a[204:205], v84 offset:12288
    ds_read_b64_tr_b16 a[206:207], v84 offset:12800
    ds_read_b64_tr_b16 a[208:209], v84 offset:16384
    ds_read_b64_tr_b16 a[210:211], v84 offset:16896
    ds_read_b64_tr_b16 a[212:213], v84 offset:20480
    ds_read_b64_tr_b16 a[214:215], v84 offset:20992
    ds_read_b64_tr_b16 a[216:217], v84 offset:24576
    ds_read_b64_tr_b16 a[218:219], v84 offset:25088
    ds_read_b64_tr_b16 a[220:221], v84 offset:28672
    ds_read_b64_tr_b16 a[222:223], v84 offset:29184
    ds_read_b64_tr_b16 a[224:225], v84 offset:32768
    ds_read_b64_tr_b16 a[226:227], v84 offset:33280
    ds_read_b64_tr_b16 a[228:229], v84 offset:36864
    ds_read_b64_tr_b16 a[230:231], v84 offset:37376
    ds_read_b64_tr_b16 a[232:233], v84 offset:40960
    ds_read_b64_tr_b16 a[234:235], v84 offset:41472
    ds_read_b64_tr_b16 a[236:237], v84 offset:45056
    ds_read_b64_tr_b16 a[238:239], v84 offset:45568
    ds_read_b64_tr_b16 a[240:241], v84 offset:49152
    ds_read_b64_tr_b16 a[242:243], v84 offset:49664
    ds_read_b64_tr_b16 a[244:245], v84 offset:53248
    ds_read_b64_tr_b16 a[246:247], v84 offset:53760
    ds_read_b64_tr_b16 a[248:249], v84 offset:57344
    ds_read_b64_tr_b16 a[250:251], v84 offset:57856
    ds_read_b64_tr_b16 a[252:253], v84 offset:61440
    ds_read_b64_tr_b16 a[254:255], v84 offset:61952
    buffer_load_dword v247, v15, s[20:23], 0 offen sc1
    ds_read_b128 v[134:137], v5 offset:0
    ds_read_b128 v[138:141], v5 offset:1024
    ds_read_b128 v[142:145], v5 offset:2048
    ds_read_b128 v[146:149], v5 offset:3072
    ds_read_b128 v[150:153], v5 offset:4096
    ds_read_b128 v[154:157], v5 offset:5120
    ds_read_b128 v[158:161], v5 offset:6144
    ds_read_b128 v[162:165], v5 offset:7168
    ds_read_b128 v[166:169], v5 offset:8192
    ds_read_b128 v[170:173], v5 offset:9216
    s_waitcnt lgkmcnt(8)
    v_mfma_f32_16x16x32_bf16 v[50:53], a[192:195], v[134:137], v[50:53]
    v_mfma_f32_16x16x32_bf16 v[50:53], a[196:199], v[138:141], v[50:53]
    s_waitcnt lgkmcnt(6)
    v_mfma_f32_16x16x32_bf16 v[54:57], a[192:195], v[142:145], v[54:57]
    v_mfma_f32_16x16x32_bf16 v[54:57], a[196:199], v[146:149], v[54:57]
    s_waitcnt lgkmcnt(4)
    v_mfma_f32_16x16x32_bf16 v[58:61], a[192:195], v[150:153], v[58:61]
    v_mfma_f32_16x16x32_bf16 v[58:61], a[196:199], v[154:157], v[58:61]
    s_waitcnt lgkmcnt(2)
    v_mfma_f32_16x16x32_bf16 v[62:65], a[192:195], v[158:161], v[62:65]
    v_mfma_f32_16x16x32_bf16 v[62:65], a[196:199], v[162:165], v[62:65]
    s_waitcnt lgkmcnt(0)
    v_mfma_f32_16x16x32_bf16 v[66:69], a[192:195], v[166:169], v[66:69]
    v_mfma_f32_16x16x32_bf16 v[66:69], a[196:199], v[170:173], v[66:69]
    s_mov_b32 s57, 0
    s_barrier
    s_waitcnt vmcnt(0)
    v_cmp_ne_u32 vcc, s53, v247
    s_cbranch_vccz L_fd_6
L_fa_4:
    buffer_load_dword v247, v15, s[20:23], 0 offen sc1
    s_add_u32 s57, s57, 1
    s_cmp_gt_u32 s57, 48
    s_waitcnt vmcnt(0)
    s_cbranch_scc1 L_fs_5
    v_cmp_ne_u32 vcc, s53, v247
    s_nop 0
    s_cbranch_vccnz L_fa_4
L_fd_6:
    s_add_u32 m0, s58, 2048
    s_mov_b32 s59, 61440
    buffer_load_dwordx4 v6, s[20:23], s59 offen offset:0 sc1 lds
    buffer_load_dwordx4 v7, s[20:23], s59 offen offset:1024 sc1 lds
    buffer_load_dwordx4 v8, s[20:23], s59 offen offset:2048 sc1 lds
    s_mov_b32 exec_hi, 0
    buffer_load_dwordx4 v9, s[20:23], s59 offen offset:3072 sc1 lds
    s_mov_b32 exec_hi, -1
    s_add_u32 m0, s58, 18432
    s_mov_b32 s59, 77824
    buffer_load_dwordx4 v6, s[20:23], s59 offen offset:0 sc1 lds
    buffer_load_dwordx4 v7, s[20:23], s59 offen offset:1024 sc1 lds
    buffer_load_dwordx4 v8, s[20:23], s59 offen offset:2048 sc1 lds
    s_mov_b32 exec_hi, 0
    buffer_load_dwordx4 v9, s[20:23], s59 offen offset:3072 sc1 lds
    s_mov_b32 exec_hi, -1
    s_waitcnt vmcnt(4)
    s_barrier
    ds_read_b128 v[134:137], v3 offset:2048
    ds_read_b128 v[138:141], v3 offset:3072
    s_add_u32 m0, s58, 34816
    s_mov_b32 s59, 94208
    buffer_load_dwordx4 v6, s[20:23], s59 offen offset:0 sc1 lds
    ds_read_b128 v[142:145], v3 offset:4096
    ds_read_b128 v[146:149], v3 offset:5120
    ds_read_b128 v[150:153], v3 offset:6144
    buffer_load_dwordx4 v7, s[20:23], s59 offen offset:1024 sc1 lds
    ds_read_b128 v[154:157], v3 offset:7168
    ds_read_b128 v[158:161], v3 offset:8192
    ds_read_b128 v[162:165], v3 offset:9216
    buffer_load_dwordx4 v8, s[20:23], s59 offen offset:2048 sc1 lds
    ds_read_b128 v[166:169], v3 offset:10240
    s_waitcnt lgkmcnt(7)
    v_mfma_f32_16x16x32_bf16 v[50:53], a[200:203], v[134:137], v[50:53]
    ds_read_b128 v[170:173], v3 offset:11264
    v_mfma_f32_16x16x32_bf16 v[50:53], a[204:207], v[138:141], v[50:53]
    ds_read_b128 v[174:177], v3 offset:12288
    s_waitcnt lgkmcnt(7)
    v_mfma_f32_16x16x32_bf16 v[50:53], a[208:211], v[142:145], v[50:53]
    s_mov_b32 exec_hi, 0
    buffer_load_dwordx4 v9, s[20:23], s59 offen offset:3072 sc1 lds
    s_mov_b32 exec_hi, -1
    ds_read_b128 v[178:181], v3 offset:13312
    v_mfma_f32_16x16x32_bf16 v[50:53], a[212:215], v[146:149], v[50:53]
    ds_read_b128 v[134:137], v3 offset:14336
    s_waitcnt lgkmcnt(7)
    v_mfma_f32_16x16x32_bf16 v[50:53], a[216:219], v[150:153], v[50:53]
    ds_read_b128 v[138:141], v3 offset:15360
    v_mfma_f32_16x16x32_bf16 v[50:53], a[220:223], v[154:157], v[50:53]
    s_add_u32 m0, s58, 51200
    s_mov_b32 s59, 110592
    buffer_load_dwordx4 v6, s[20:23], s59 offen offset:0 sc1 lds
    s_waitcnt vmcnt(5)
    s_barrier
    ds_read_b128 v[142:145], v3 offset:18432
    s_waitcnt lgkmcnt(7)
    v_mfma_f32_16x16x32_bf16 v[50:53], a[224:227], v[158:161], v[50:53]
    ds_read_b128 v[146:149], v3 offset:19456
    v_mfma_f32_16x16x32_bf16 v[50:53], a[228:231], v[162:165], v[50:53]
    ds_read_b128 v[150:153], v3 offset:20480
    s_waitcnt lgkmcnt(7)
    v_mfma_f32_16x16x32_bf16 v[50:53], a[232:235], v[166:169], v[50:53]
    buffer_load_dwordx4 v7, s[20:23], s59 offen offset:1024 sc1 lds
    ds_read_b128 v[154:157], v3 offset:21504
    v_mfma_f32_16x16x32_bf16 v[50:53], a[236:239], v[170:173], v[50:53]
    ds_read_b128 v[158:161], v3 offset:22528
    s_waitcnt lgkmcnt(7)
    v_mfma_f32_16x16x32_bf16 v[50:53], a[240:243], v[174:177], v[50:53]
    ds_read_b128 v[162:165], v3 offset:23552
    v_mfma_f32_16x16x32_bf16 v[50:53], a[244:247], v[178:181], v[50:53]
    buffer_load_dwordx4 v8, s[20:23], s59 offen offset:2048 sc1 lds
    ds_read_b128 v[166:169], v3 offset:24576
    s_waitcnt lgkmcnt(7)
    v_mfma_f32_16x16x32_bf16 v[50:53], a[248:251], v[134:137], v[50:53]
    ds_read_b128 v[170:173], v3 offset:25600
    v_mfma_f32_16x16x32_bf16 v[50:53], a[252:255], v[138:141], v[50:53]
    ds_read_b128 v[174:177], v3 offset:26624
    s_waitcnt lgkmcnt(7)
    v_mfma_f32_16x16x32_bf16 v[54:57], a[200:203], v[142:145], v[54:57]
    s_mov_b32 exec_hi, 0
    buffer_load_dwordx4 v9, s[20:23], s59 offen offset:3072 sc1 lds
    s_mov_b32 exec_hi, -1
    ds_read_b128 v[178:181], v3 offset:27648
    v_mfma_f32_16x16x32_bf16 v[54:57], a[204:207], v[146:149], v[54:57]
    ds_read_b128 v[134:137], v3 offset:28672
    s_waitcnt lgkmcnt(7)
    v_mfma_f32_16x16x32_bf16 v[54:57], a[208:211], v[150:153], v[54:57]
    ds_read_b128 v[138:141], v3 offset:29696
    v_mfma_f32_16x16x32_bf16 v[54:57], a[212:215], v[154:157], v[54:57]
    s_add_u32 m0, s58, 67584
    s_mov_b32 s59, 126976
    buffer_load_dwordx4 v6, s[20:23], s59 offen offset:0 sc1 lds
    ds_read_b128 v[142:145], v3 offset:30720
    s_waitcnt lgkmcnt(7)
    v_mfma_f32_16x16x32_bf16 v[54:57], a[216:219], v[158:161], v[54:57]
    ds_read_b128 v[146:149], v3 offset:31744
    v_mfma_f32_16x16x32_bf16 v[54:57], a[220:223], v[162:165], v[54:57]
    s_waitcnt vmcnt(5)
    s_barrier
    ds_read_b128 v[150:153], v3 offset:34816
    s_waitcnt lgkmcnt(7)
    v_mfma_f32_16x16x32_bf16 v[54:57], a[224:227], v[166:169], v[54:57]
    buffer_load_dwordx4 v7, s[20:23], s59 offen offset:1024 sc1 lds
    ds_read_b128 v[154:157], v3 offset:35840
    v_mfma_f32_16x16x32_bf16 v[54:57], a[228:231], v[170:173], v[54:57]
    ds_read_b128 v[158:161], v3 offset:36864
    s_waitcnt lgkmcnt(7)
    v_mfma_f32_16x16x32_bf16 v[54:57], a[232:235], v[174:177], v[54:57]
    ds_read_b128 v[162:165], v3 offset:37888
    v_mfma_f32_16x16x32_bf16 v[54:57], a[236:239], v[178:181], v[54:57]
    buffer_load_dwordx4 v8, s[20:23], s59 offen offset:2048 sc1 lds
    ds_read_b128 v[166:169], v3 offset:38912
    s_waitcnt lgkmcnt(7)
    v_mfma_f32_16x16x32_bf16 v[54:57], a[240:243], v[134:137], v[54:57]
    ds_read_b128 v[170:173], v3 offset:39936
    v_mfma_f32_16x16x32_bf16 v[54:57], a[244:247], v[138:141], v[54:57]
    ds_read_b128 v[174:177], v3 offset:40960
    s_waitcnt lgkmcnt(7)
    v_mfma_f32_16x16x32_bf16 v[54:57], a[248:251], v[142:145], v[54:57]
    s_mov_b32 exec_hi, 0
    buffer_load_dwordx4 v9, s[20:23], s59 offen offset:3072 sc1 lds
    s_mov_b32 exec_hi, -1
    ds_read_b128 v[178:181], v3 offset:41984
    v_mfma_f32_16x16x32_bf16 v[54:57], a[252:255], v[146:149], v[54:57]
    ds_read_b128 v[134:137], v3 offset:43008
    s_waitcnt lgkmcnt(7)
    v_mfma_f32_16x16x32_bf16 v[58:61], a[200:203], v[150:153], v[58:61]
    ds_read_b128 v[138:141], v3 offset:44032
    v_mfma_f32_16x16x32_bf16 v[58:61], a[204:207], v[154:157], v[58:61]
    s_lshl_b32 s62, s67, 6
    s_add_u32 m0, s63, 81920
    s_nop 0
    buffer_load_dwordx4 v96, s[24:27], s62 offen offset:0 lds
    ds_read_b128 v[142:145], v3 offset:45056
    s_waitcnt lgkmcnt(7)
    v_mfma_f32_16x16x32_bf16 v[58:61], a[208:211], v[158:161], v[58:61]
    ds_read_b128 v[146:149], v3 offset:46080
    v_mfma_f32_16x16x32_bf16 v[58:61], a[212:215], v[162:165], v[58:61]
    ds_read_b128 v[150:153], v3 offset:47104
    s_waitcnt lgkmcnt(7)
    v_mfma_f32_16x16x32_bf16 v[58:61], a[216:219], v[166:169], v[58:61]
    s_add_u32 s62, s62, 43008
    buffer_load_dwordx4 v96, s[24:27], s62 offen offset:1024 lds
    ds_read_b128 v[154:157], v3 offset:48128
    v_mfma_f32_16x16x32_bf16 v[58:61], a[220:223], v[170:173], v[58:61]
    s_waitcnt vmcnt(6)
    s_barrier
    ds_read_b128 v[158:161], v3 offset:51200
    s_waitcnt lgkmcnt(7)
    v_mfma_f32_16x16x32_bf16 v[58:61], a[224:227], v[174:177], v[58:61]
    ds_read_b128 v[162:165], v3 offset:52224
    v_mfma_f32_16x16x32_bf16 v[58:61], a[228:231], v[178:181], v[58:61]
    s_add_u32 s62, s62, 43008
    buffer_load_dwordx4 v96, s[24:27], s62 offen offset:2048 lds
    ds_read_b128 v[166:169], v3 offset:53248
    s_waitcnt lgkmcnt(7)
    v_mfma_f32_16x16x32_bf16 v[58:61], a[232:235], v[134:137], v[58:61]
    ds_read_b128 v[170:173], v3 offset:54272
    v_mfma_f32_16x16x32_bf16 v[58:61], a[236:239], v[138:141], v[58:61]
    ds_read_b128 v[174:177], v3 offset:55296
    s_waitcnt lgkmcnt(7)
    v_mfma_f32_16x16x32_bf16 v[58:61], a[240:243], v[142:145], v[58:61]
    s_add_u32 s62, s62, 43008
    buffer_load_dwordx4 v96, s[24:27], s62 offen offset:3072 lds
    ds_read_b128 v[178:181], v3 offset:56320
    v_mfma_f32_16x16x32_bf16 v[58:61], a[244:247], v[146:149], v[58:61]
    ds_read_b128 v[134:137], v3 offset:57344
    s_waitcnt lgkmcnt(7)
    v_mfma_f32_16x16x32_bf16 v[58:61], a[248:251], v[150:153], v[58:61]
    ds_read_b128 v[138:141], v3 offset:58368
    v_mfma_f32_16x16x32_bf16 v[58:61], a[252:255], v[154:157], v[58:61]
    s_add_u32 s62, s62, 47104
    s_add_u32 m0, s63, 86016
    s_nop 0
    buffer_load_dwordx4 v96, s[24:27], s62 offen offset:0 lds
    ds_read_b128 v[142:145], v3 offset:59392
    s_waitcnt lgkmcnt(7)
    v_mfma_f32_16x16x32_bf16 v[62:65], a[200:203], v[158:161], v[62:65]
    ds_read_b128 v[146:149], v3 offset:60416
    v_mfma_f32_16x16x32_bf16 v[62:65], a[204:207], v[162:165], v[62:65]
    ds_read_b128 v[150:153], v3 offset:61440
    s_waitcnt lgkmcnt(7)
    v_mfma_f32_16x16x32_bf16 v[62:65], a[208:211], v[166:169], v[62:65]
    s_add_u32 s62, s62, 43008
    buffer_load_dwordx4 v96, s[24:27], s62 offen offset:1024 lds
    ds_read_b128 v[154:157], v3 offset:62464
    v_mfma_f32_16x16x32_bf16 v[62:65], a[212:215], v[170:173], v[62:65]
    ds_read_b128 v[158:161], v3 offset:63488
    s_waitcnt lgkmcnt(7)
    v_mfma_f32_16x16x32_bf16 v[62:65], a[216:219], v[174:177], v[62:65]
    ds_read_b128 v[162:165], v3 offset:64512
    v_mfma_f32_16x16x32_bf16 v[62:65], a[220:223], v[178:181], v[62:65]
    s_add_u32 s62, s62, 43008
    buffer_load_dwordx4 v96, s[24:27], s62 offen offset:2048 lds
    s_waitcnt vmcnt(7)
    s_barrier
    ds_read_b128 v[166:169], v4 offset:2048
    s_waitcnt lgkmcnt(7)
    v_mfma_f32_16x16x32_bf16 v[62:65], a[224:227], v[134:137], v[62:65]
    ds_read_b128 v[170:173], v4 offset:3072
    v_mfma_f32_16x16x32_bf16 v[62:65], a[228:231], v[138:141], v[62:65]
    ds_read_b128 v[174:177], v4 offset:4096
    s_waitcnt lgkmcnt(7)
    v_mfma_f32_16x16x32_bf16 v[62:65], a[232:235], v[142:145], v[62:65]
    s_add_u32 s62, s62, 43008
    buffer_load_dwordx4 v96, s[24:27], s62 offen offset:3072 lds
    ds_read_b128 v[178:181], v4 offset:5120
    v_mfma_f32_16x16x32_bf16 v[62:65], a[236:239], v[146:149], v[62:65]
    ds_read_b128 v[134:137], v4 offset:6144
    s_waitcnt lgkmcnt(7)
    v_mfma_f32_16x16x32_bf16 v[62:65], a[240:243], v[150:153], v[62:65]
    ds_read_b128 v[138:141], v4 offset:7168
    v_mfma_f32_16x16x32_bf16 v[62:65], a[244:247], v[154:157], v[62:65]
    ds_read_b128 v[142:145], v4 offset:8192
    s_waitcnt lgkmcnt(7)
    v_mfma_f32_16x16x32_bf16 v[62:65], a[248:251], v[158:161], v[62:65]
    ds_read_b128 v[146:149], v4 offset:9216
    v_mfma_f32_16x16x32_bf16 v[62:65], a[252:255], v[162:165], v[62:65]
    ds_read_b128 v[150:153], v4 offset:10240
    s_waitcnt lgkmcnt(7)
    v_mfma_f32_16x16x32_bf16 v[66:69], a[200:203], v[166:169], v[66:69]
    ds_read_b128 v[154:157], v4 offset:11264
    v_mfma_f32_16x16x32_bf16 v[66:69], a[204:207], v[170:173], v[66:69]
    ds_read_b128 v[158:161], v4 offset:12288
    s_waitcnt lgkmcnt(7)
    v_mfma_f32_16x16x32_bf16 v[66:69], a[208:211], v[174:177], v[66:69]
    ds_read_b128 v[162:165], v4 offset:13312
    v_mfma_f32_16x16x32_bf16 v[66:69], a[212:215], v[178:181], v[66:69]
    ds_read_b128 v[166:169], v4 offset:14336
    s_waitcnt lgkmcnt(7)
    v_mfma_f32_16x16x32_bf16 v[66:69], a[216:219], v[134:137], v[66:69]
    ds_read_b128 v[170:173], v4 offset:15360
    v_mfma_f32_16x16x32_bf16 v[66:69], a[220:223], v[138:141], v[66:69]
    s_waitcnt lgkmcnt(6)
    v_mfma_f32_16x16x32_bf16 v[66:69], a[224:227], v[142:145], v[66:69]
    v_mfma_f32_16x16x32_bf16 v[66:69], a[228:231], v[146:149], v[66:69]
    s_waitcnt lgkmcnt(4)
    v_mfma_f32_16x16x32_bf16 v[66:69], a[232:235], v[150:153], v[66:69]
    v_mfma_f32_16x16x32_bf16 v[66:69], a[236:239], v[154:157], v[66:69]
    s_waitcnt lgkmcnt(2)
    v_mfma_f32_16x16x32_bf16 v[66:69], a[240:243], v[158:161], v[66:69]
    v_mfma_f32_16x16x32_bf16 v[66:69], a[244:247], v[162:165], v[66:69]
    s_waitcnt lgkmcnt(0)
    v_mfma_f32_16x16x32_bf16 v[66:69], a[248:251], v[166:169], v[66:69]
    v_mfma_f32_16x16x32_bf16 v[66:69], a[252:255], v[170:173], v[66:69]
    v_cvt_pk_bf16_f32 v102, v54, v55
    v_cvt_pk_bf16_f32 v103, v56, v57
    v_cvt_pk_bf16_f32 v104, v58, v59
    v_cvt_pk_bf16_f32 v105, v60, v61
    v_cvt_pk_bf16_f32 v106, v62, v63
    v_cvt_pk_bf16_f32 v107, v64, v65
    s_nop 1
    v_cvt_pk_bf16_f32 v108, v66, v67
    v_cvt_pk_bf16_f32 v109, v68, v69
    v_cvt_pk_bf16_f32 v110, v50, v51
    v_cvt_pk_bf16_f32 v111, v52, v53
    v_permlane16_swap_b32 v102, v104
    v_permlane16_swap_b32 v103, v105
    v_permlane16_swap_b32 v106, v108
    v_permlane16_swap_b32 v107, v109
    v_permlane16_swap_b32 v110, v112
    v_permlane16_swap_b32 v111, v113
    s_cmp_lg_u32 s6, 0
    s_cbranch_scc1 L_slow_7
    s_mov_b32 s0, 2703360
    buffer_store_dwordx4 v[102:105], v10, s[20:23], s0 offen
    s_mov_b32 s0, 2736128
    buffer_store_dwordx4 v[106:109], v10, s[20:23], s0 offen
    s_mov_b32 exec_lo, 0xffff
    s_mov_b32 exec_hi, 0xffff
    s_mov_b32 s0, 2686976
    buffer_store_dwordx4 v[110:113], v10, s[20:23], s0 offen
    s_mov_b64 exec, -1
L_back_8:
    ds_write_b128 v11, v[102:105] offset:2048
    ds_write_b128 v11, v[106:109] offset:6144
    s_mov_b32 exec_lo, 0xffff
    s_mov_b32 exec_hi, 0xffff
    ds_write_b128 v11, v[110:113] offset:0
    s_mov_b64 exec, -1
    s_lshl_b32 s0, s3, 11
    v_add_u32 v246, s0, v5
    s_cmp_eq_u32 s3, 0
    s_cselect_b32 s0, 63, 15
    s_cselect_b32 s1, 256, 0
    v_and_b32 v247, s0, v0
    v_lshl_add_u32 v247, v247, 4, s1
    s_waitcnt lgkmcnt(0)
    s_barrier
    ds_read_b128 v[134:137], v246 offset:2048
    ds_read_b128 v[138:141], v246 offset:3072
    s_waitcnt lgkmcnt(0)
    v_mfma_f32_16x16x32_bf16 v[146:149], v[134:137], v[134:137], 0
    v_mfma_f32_16x16x32_bf16 v[146:149], v[138:141], v[138:141], v[146:149]
    v_mfma_f32_16x16x32_bf16 v[142:145], v[38:41], v[134:137], 0
    v_mfma_f32_16x16x32_bf16 v[142:145], v[42:45], v[138:141], v[142:145]
    ds_read_b128 v[154:157], v5 offset:2048
    ds_read_b128 v[158:161], v5 offset:3072
    ds_read_b128 v[162:165], v5 offset:4096
    ds_read_b128 v[166:169], v5 offset:5120
    s_nop 1
    v_cndmask_b32 v146, v146, v147, s[46:47]
    v_cndmask_b32 v148, v148, v149, s[46:47]
    v_cndmask_b32 v144, v146, v148, s[48:49]
    v_mov_b32 v145, 0
    s_waitcnt vmcnt(0)
    s_cmp_lg_u32 s6, 0
    s_cbranch_scc1 L_slow_9
    s_mov_b64 exec, s[44:45]
    buffer_store_dwordx4 v[142:145], v14, s[20:23], 0 offen offset:256
    s_mov_b64 exec, -1
L_back_10:
    ds_read_b128 v[170:173], v5 offset:6144
    ds_read_b128 v[174:177], v5 offset:7168
    ds_read_b128 v[178:181], v5 offset:8192
    ds_read_b128 v[182:185], v5 offset:9216
    s_cmp_eq_u32 s3, 3
    s_cbranch_scc0 L_nz_11
    ds_read_b128 v[134:137], v5 offset:0
    ds_read_b128 v[138:141], v5 offset:1024
    v_subrev_u32 v246, 768, v14
    s_waitcnt lgkmcnt(0)
    v_mfma_f32_16x16x32_bf16 v[146:149], v[134:137], v[134:137], 0
    v_mfma_f32_16x16x32_bf16 v[146:149], v[138:141], v[138:141], v[146:149]
    v_mfma_f32_16x16x32_bf16 v[150:153], v[38:41], v[134:137], 0
    v_mfma_f32_16x16x32_bf16 v[150:153], v[42:45], v[138:141], v[150:153]
    s_nop 5
    v_cndmask_b32 v146, v146, v147, s[46:47]
    v_cndmask_b32 v148, v148, v149, s[46:47]
    v_cndmask_b32 v152, v146, v148, s[48:49]
    v_mov_b32 v153, 0
    s_cmp_lg_u32 s6, 0
    s_cbranch_scc1 L_slow_12
    s_mov_b64 exec, s[44:45]
    buffer_store_dwordx4 v[150:153], v246, s[20:23], 0 offen
    s_mov_b64 exec, -1
L_back_13:
L_nz_11:
    s_waitcnt lgkmcnt(6)
    v_mfma_f32_16x16x32_bf16 v[198:201], a[0:3], v[154:157], 0
    v_lshrrev_b32 v124, 2, v1
    v_lshl_add_u32 v124, v2, 3, v124
    v_mfma_f32_16x16x32_bf16 v[202:205], a[4:7], v[154:157], 0
    v_lshlrev_b32 v124, 6, v124
    v_and_b32 v131, 3, v0
    v_mfma_f32_16x16x32_bf16 v[206:209], v[154:157], a[8:11], 0
    v_lshl_add_u32 v124, v131, 3, v124
    v_and_b32 v131, 1, v2
    v_mfma_f32_16x16x32_bf16 v[198:201], a[12:15], v[158:161], v[198:201]
    v_lshl_add_u32 v124, v131, 5, v124
    v_add_u32 v124, s63, v124
    v_mfma_f32_16x16x32_bf16 v[202:205], a[16:19], v[158:161], v[202:205]
    v_add_u32 v124, 81920, v124
    v_xor_b32 v125, 32, v124
    v_mfma_f32_16x16x32_bf16 v[206:209], v[158:161], a[20:23], v[206:209]
    v_lshlrev_b32 v129, 4, v2
    v_lshl_add_u32 v126, s3, 8, v129
    s_waitcnt lgkmcnt(4)
    v_mfma_f32_16x16x32_bf16 v[210:213], a[0:3], v[162:165], 0
    v_add_u32 v126, 160768, v126
    v_lshrrev_b32 v127, 3, v1
    v_mfma_f32_16x16x32_bf16 v[214:217], a[4:7], v[162:165], 0
    v_lshl_add_u32 v127, v127, 2, v2
    v_and_b32 v131, 7, v1
    v_mfma_f32_16x16x32_bf16 v[218:221], v[162:165], a[8:11], 0
    v_lshl_add_u32 v127, v127, 3, v131
    v_lshlrev_b32 v127, 2, v127
    v_mfma_f32_16x16x32_bf16 v[210:213], a[12:15], v[166:169], v[210:213]
    v_add_u32 v127, 160768, v127
    v_lshlrev_b32 v128, 4, v1
    v_mfma_f32_16x16x32_bf16 v[214:217], a[16:19], v[166:169], v[214:217]
    v_lshl_add_u32 v128, s3, 8, v128
    v_lshl_add_u32 v130, v2, 13, v128
    v_mfma_f32_16x16x32_bf16 v[218:221], v[166:169], a[20:23], v[218:221]
    v_lshl_add_u32 v128, v2, 3, v128
    v_lshlrev_b32 v131, 4, v131
    s_cmp_gt_u32 s3, 0
    s_cbranch_scc1 L_ng_18
    s_add_u32 s0, s100, 0
    buffer_load_dwordx4 v[134:137], v247, s[20:23], s0 offen offset:0 sc1
    buffer_load_dwordx4 v[138:141], v247, s[20:23], s0 offen offset:3072 sc1
    s_add_u32 s0, s100, 6144
    buffer_load_dwordx4 v[142:145], v247, s[20:23], s0 offen offset:0 sc1
    buffer_load_dwordx4 v[146:149], v247, s[20:23], s0 offen offset:3072 sc1
    s_add_u32 s0, s100, 12288
    buffer_load_dwordx4 v[150:153], v247, s[20:23], s0 offen offset:0 sc1
    buffer_load_dwordx4 v[154:157], v247, s[20:23], s0 offen offset:3072 sc1
    s_add_u32 s0, s100, 18432
    buffer_load_dwordx4 v[158:161], v247, s[20:23], s0 offen offset:0 sc1
    buffer_load_dwordx4 v[162:165], v247, s[20:23], s0 offen offset:3072 sc1
L_ng_18:
    s_waitcnt lgkmcnt(2)
    v_mfma_f32_16x16x32_bf16 v[222:225], a[0:3], v[170:173], 0
    v_subrev_u32 v118, 0, v131
    v_cmp_gt_u32 vcc, 32, v118
    v_mfma_f32_16x16x32_bf16 v[226:229], a[4:7], v[170:173], 0
    v_bfm_b32 v118, 16, v118
    s_nop 0
    v_mfma_f32_16x16x32_bf16 v[230:233], v[170:173], a[8:11], 0
    v_cndmask_b32 v118, 0, v118, vcc
    v_subrev_u32 v119, 32, v131
    v_mfma_f32_16x16x32_bf16 v[222:225], a[12:15], v[174:177], v[222:225]
    v_cmp_gt_u32 vcc, 32, v119
    v_bfm_b32 v119, 16, v119
    v_mfma_f32_16x16x32_bf16 v[226:229], a[16:19], v[174:177], v[226:229]
    s_nop 0
    v_cndmask_b32 v119, 0, v119, vcc
    v_mfma_f32_16x16x32_bf16 v[230:233], v[174:177], a[20:23], v[230:233]
    v_subrev_u32 v120, 64, v131
    v_cmp_gt_u32 vcc, 32, v120
    s_waitcnt lgkmcnt(0)
    v_mfma_f32_16x16x32_bf16 v[234:237], a[0:3], v[178:181], 0
    v_bfm_b32 v120, 16, v120
    s_nop 0
    v_mfma_f32_16x16x32_bf16 v[238:241], a[4:7], v[178:181], 0
    v_cndmask_b32 v120, 0, v120, vcc
    v_subrev_u32 v121, 96, v131
    v_mfma_f32_16x16x32_bf16 v[242:245], v[178:181], a[8:11], 0
    v_cmp_gt_u32 vcc, 32, v121
    v_bfm_b32 v121, 16, v121
    v_mfma_f32_16x16x32_bf16 v[234:237], a[12:15], v[182:185], v[234:237]
    s_nop 0
    v_cndmask_b32 v121, 0, v121, vcc
    v_mfma_f32_16x16x32_bf16 v[238:241], a[16:19], v[182:185], v[238:241]
    s_lshl_b32 s66, s7, 10
    s_add_u32 s66, s66, 6225920
    v_mfma_f32_16x16x32_bf16 v[242:245], v[182:185], a[20:23], v[242:245]
    s_cmp_lt_i32 s7, 0
    s_cselect_b32 s66, 8388608, s66
    s_cmp_gt_u32 s3, 0
    s_cbranch_scc1 L_nog_14
    s_waitcnt vmcnt(5)
    v_or3_b32 v246, v137, v141, v145
    v_add_f32 v136, v136, v140
    v_add_f32 v136, v136, v144
    v_pk_add_f32 v[134:135], v[134:135], v[138:139]
    v_pk_add_f32 v[134:135], v[134:135], v[142:143]
    s_waitcnt vmcnt(3)
    v_or3_b32 v246, v246, v149, v153
    v_pk_add_f32 v[134:135], v[134:135], v[146:147]
    v_add_f32 v136, v136, v148
    v_pk_add_f32 v[134:135], v[134:135], v[150:151]
    v_add_f32 v136, v136, v152
    s_waitcnt vmcnt(1)
    v_or3_b32 v246, v246, v157, v161
    v_pk_add_f32 v[134:135], v[134:135], v[154:155]
    v_add_f32 v136, v136, v156
    v_pk_add_f32 v[134:135], v[134:135], v[158:159]
    v_add_f32 v136, v136, v160
    s_waitcnt vmcnt(0)
    v_or_b32 v246, v246, v165
    v_cmp_ne_u32 vcc, 0, v246
    v_pk_add_f32 v[134:135], v[134:135], v[162:163]
    v_add_f32 v136, v136, v164
    s_cbranch_vccz L_gok_17
    s_mov_b32 s57, 0
L_poll_19:
    s_add_u32 s0, s100, 0
    buffer_load_dwordx4 v[134:137], v247, s[20:23], s0 offen offset:0 sc1
    buffer_load_dwordx4 v[138:141], v247, s[20:23], s0 offen offset:3072 sc1
    s_add_u32 s0, s100, 6144
    buffer_load_dwordx4 v[142:145], v247, s[20:23], s0 offen offset:0 sc1
    buffer_load_dwordx4 v[146:149], v247, s[20:23], s0 offen offset:3072 sc1
    s_add_u32 s0, s100, 12288
    buffer_load_dwordx4 v[150:153], v247, s[20:23], s0 offen offset:0 sc1
    buffer_load_dwordx4 v[154:157], v247, s[20:23], s0 offen offset:3072 sc1
    s_add_u32 s0, s100, 18432
    buffer_load_dwordx4 v[158:161], v247, s[20:23], s0 offen offset:0 sc1
    buffer_load_dwordx4 v[162:165], v247, s[20:23], s0 offen offset:3072 sc1
    s_waitcnt vmcnt(5)
    v_or3_b32 v246, v137, v141, v145
    v_add_f32 v136, v136, v140
    v_add_f32 v136, v136, v144
    v_pk_add_f32 v[134:135], v[134:135], v[138:139]
    v_pk_add_f32 v[134:135], v[134:135], v[142:143]
    s_waitcnt vmcnt(3)
    v_or3_b32 v246, v246, v149, v153
    v_pk_add_f32 v[134:135], v[134:135], v[146:147]
    v_add_f32 v136, v136, v148
    v_pk_add_f32 v[134:135], v[134:135], v[150:151]
    v_add_f32 v136, v136, v152
    s_waitcnt vmcnt(1)
    v_or3_b32 v246, v246, v157, v161
    v_pk_add_f32 v[134:135], v[134:135], v[154:155]
    v_add_f32 v136, v136, v156
    v_pk_add_f32 v[134:135], v[134:135], v[158:159]
    v_add_f32 v136, v136, v160
    s_waitcnt vmcnt(0)
    v_or_b32 v246, v246, v165
    v_cmp_ne_u32 vcc, 0, v246
    v_pk_add_f32 v[134:135], v[134:135], v[162:163]
    v_add_f32 v136, v136, v164
    s_add_u32 s57, s57, 1
    s_cmp_gt_u32 s57, 200000
    s_cbranch_scc1 L_end
    s_cbranch_vccnz L_poll_19
L_gok_17:
    s_barrier
    v_mul_f32 v138, 0xbb000000, v134
    s_add_u32 m0, s58, 18432
    s_mov_b32 s59, 2699264
    buffer_load_dwordx4 v6, s[20:23], s59 offen offset:0 sc1 lds
    v_mul_f32 v145, 0x3b000000, v136
    v_fma_f32 v145, -v138, v138, v145
    v_max_f32 v145, 0, v145
    v_add_f32 v144, 0x3727c5ac, v145
    v_rsq_f32 v144, v144
    buffer_load_dwordx4 v7, s[20:23], s59 offen offset:1024 sc1 lds
    v_fma_f32 v142, v138, s52, v135
    v_mul_f32 v142, v142, v144
    v_add_f32 v140, 1.0, v144
    v_mul_f32 v141, v138, v144
    v_max_f32_dpp v146, v142, v142 row_ror:8 row_mask:0xf bank_mask:0xf
    buffer_load_dwordx4 v8, s[20:23], s59 offen offset:2048 sc1 lds
    v_mul_f32 v246, v140, v140
    v_fmaak_f32 v246, v246, v145, 0x3727c5ac
    v_max_f32_dpp v146, v146, v146 row_ror:4 row_mask:0xf bank_mask:0xf
    v_rsq_f32 v246, v246
    v_add_u32 v248, 157696, v247
    s_mov_b32 exec_hi, 0
    buffer_load_dwordx4 v9, s[20:23], s59 offen offset:3072 sc1 lds
    s_mov_b32 exec_hi, -1
    v_max_f32_dpp v146, v146, v146 row_ror:2 row_mask:0xf bank_mask:0xf
    v_mul_f32 v139, v140, v246
    v_lshrrev_b32 v249, 2, v247
    v_max_f32_dpp v146, v146, v146 row_ror:1 row_mask:0xf bank_mask:0xf
    v_mov_b32 v147, v146
    v_add_u32 v249, 158976, v249
    ds_write_b128 v248, v[138:141]
    ds_write2_b32 v249, v138, v139 offset0:0 offset1:80
    v_permlane32_swap_b32 v146, v147
    v_lshrrev_b32 v248, 2, v0
    v_max_f32 v146, v146, v147
    v_mov_b32 v147, v146
    v_lshlrev_b32 v248, 8, v248
    v_and_b32 v249, 3, v0
    v_permlane16_swap_b32 v146, v147
    v_lshl_add_u32 v143, s5, 6, v0
    v_max_f32 v146, v146, v147
    v_cmp_eq_f32 vcc, v142, v146
    v_mov_b32 v246, 0
    s_cmp_eq_u32 s4, 0
    s_cselect_b32 s0, s101, 8388608
    s_ff1_i32_b64 s1, vcc
    s_and_b32 s1, s1, 63
    s_lshl_b64 exec, 1, s1
    buffer_store_dwordx2 v[142:143], v246, s[20:23], s0 offen offset:1024 sc1
    s_mov_b64 exec, -1
    v_lshl_add_u32 v248, v249, 2, v248
    s_lshr_b32 s0, s1, 4
    s_mul_i32 s0, s0, 1792
    s_lshl4_add_u32 s0, s1, s0
    s_add_u32 s0, s0, 149504
    v_add_u32 v248, s0, v248
    s_mov_b32 exec_hi, 0
    ds_read_b32 v249, v248
    s_mov_b64 exec, -1
    v_readlane_b32 s60, v144, s1
    v_readlane_b32 s61, v141, s1
    s_add_u32 m0, s58, 34816
    s_mov_b32 s59, 2715648
    buffer_load_dwordx4 v6, s[20:23], s59 offen offset:0 sc1 lds
    buffer_load_dwordx4 v7, s[20:23], s59 offen offset:1024 sc1 lds
    buffer_load_dwordx4 v8, s[20:23], s59 offen offset:2048 sc1 lds
    s_mov_b32 exec_hi, 0
    buffer_load_dwordx4 v9, s[20:23], s59 offen offset:3072 sc1 lds
    s_mov_b32 exec_hi, -1
    s_mul_i32 s0, s4, 3072
    s_add_u32 s0, s0, s100
    v_lshlrev_b32 v246, 2, v0
    v_mov_b32 v247, s61
    s_mov_b32 exec_hi, 0
    s_waitcnt lgkmcnt(0)
    v_lshlrev_b32 v248, 16, v249
    v_and_b32 v249, 0xffff0000, v249
    v_fma_f32 v248, v248, s60, v247
    v_fma_f32 v249, v249, s60, v247
    v_cvt_pk_bf16_f32 v249, v248, v249
    buffer_store_dword v249, v246, s[20:23], s0 offen offset:2304 sc1
    s_mov_b64 exec, -1
    s_waitcnt vmcnt(6)
L_jn_15:
    s_barrier
    ds_read_b128 v[134:137], v3 offset:18432
    ds_read_b128 v[138:141], v3 offset:19456
    ds_read_b128 v[142:145], v3 offset:20480
    ds_read_b64 v[150:151], v12 offset:264
    ds_read_b64 v[152:153], v12 offset:520
    ds_read_b64 v[154:155], v12 offset:776
    ds_read_b64 v[156:157], v12 offset:1032
    v_and_b32 v246, 31, v0
    v_mul_u32_u24 v246, 2304, v246
    v_add_u32 v246, 6094848, v246
    s_mov_b32 s54, 1
    s_waitcnt lgkmcnt(6)
    v_mfma_f32_16x16x32_bf16 v[198:201], a[24:27], v[134:137], v[198:201]
    ds_read_b128 v[146:149], v3 offset:21504
    v_mfma_f32_16x16x32_bf16 v[202:205], a[28:31], v[134:137], v[202:205]
    s_lshl_b32 s62, s67, 6
    s_add_u32 m0, s63, 114688
    v_mfma_f32_16x16x32_bf16 v[206:209], v[134:137], a[32:35], v[206:209]
    buffer_load_dwordx4 v96, s[28:31], s62 offen offset:0 lds
    s_waitcnt lgkmcnt(6)
    v_mfma_f32_16x16x32_bf16 v[198:201], a[36:39], v[138:141], v[198:201]
    ds_read_b128 v[134:137], v3 offset:22528
    v_mfma_f32_16x16x32_bf16 v[202:205], a[40:43], v[138:141], v[202:205]
    s_add_u32 s62, s62, 43008
    v_mfma_f32_16x16x32_bf16 v[206:209], v[138:141], a[44:47], v[206:209]
    s_waitcnt lgkmcnt(6)
    v_mfma_f32_16x16x32_bf16 v[198:201], a[48:51], v[142:145], v[198:201]
    ds_read_b128 v[138:141], v3 offset:23552
    v_mfma_f32_16x16x32_bf16 v[202:205], a[52:55], v[142:145], v[202:205]
    buffer_load_dwordx4 v96, s[28:31], s62 offen offset:1024 lds
    v_mfma_f32_16x16x32_bf16 v[206:209], v[142:145], a[56:59], v[206:209]
    s_add_u32 s62, s62, 43008
    s_waitcnt lgkmcnt(2)
    v_mfma_f32_16x16x32_bf16 v[198:201], a[60:63], v[146:149], v[198:201]
    ds_read_b128 v[142:145], v3 offset:24576
    v_fma_f32 v54, v54, v150, v151
    v_mfma_f32_16x16x32_bf16 v[202:205], a[64:67], v[146:149], v[202:205]
    v_fma_f32 v55, v55, v150, v151
    v_fma_f32 v56, v56, v150, v151
    v_mfma_f32_16x16x32_bf16 v[206:209], v[146:149], a[68:71], v[206:209]
    buffer_load_dwordx4 v96, s[28:31], s62 offen offset:2048 lds
    s_waitcnt lgkmcnt(2)
    v_mfma_f32_16x16x32_bf16 v[198:201], a[72:75], v[134:137], v[198:201]
    ds_read_b128 v[146:149], v3 offset:25600
    v_fma_f32 v57, v57, v150, v151
    v_mfma_f32_16x16x32_bf16 v[202:205], a[76:79], v[134:137], v[202:205]
    s_add_u32 s62, s62, 43008
    v_fma_f32 v58, v58, v152, v153
    v_mfma_f32_16x16x32_bf16 v[206:209], v[134:137], a[80:83], v[206:209]
    buffer_load_dwordx2 v[248:249], v246, s[20:23], 0 offen offset:1024 sc1
    s_waitcnt lgkmcnt(2)
    v_mfma_f32_16x16x32_bf16 v[198:201], a[84:87], v[138:141], v[198:201]
    ds_read_b128 v[134:137], v3 offset:26624
    v_fma_f32 v59, v59, v152, v153
    v_mfma_f32_16x16x32_bf16 v[202:205], a[88:91], v[138:141], v[202:205]
    v_fma_f32 v60, v60, v152, v153
    v_fma_f32 v61, v61, v152, v153
    v_mfma_f32_16x16x32_bf16 v[206:209], v[138:141], a[92:95], v[206:209]
    v_fma_f32 v62, v62, v154, v155
    s_waitcnt lgkmcnt(2)
    v_mfma_f32_16x16x32_bf16 v[198:201], a[96:99], v[142:145], v[198:201]
    ds_read_b128 v[138:141], v3 offset:27648
    v_fma_f32 v63, v63, v154, v155
    v_mfma_f32_16x16x32_bf16 v[202:205], a[100:103], v[142:145], v[202:205]
    buffer_load_dwordx4 v96, s[28:31], s62 offen offset:3072 lds
    v_mfma_f32_16x16x32_bf16 v[206:209], v[142:145], a[104:107], v[206:209]
    s_add_u32 s62, s62, 47104
    s_waitcnt lgkmcnt(2)
    v_mfma_f32_16x16x32_bf16 v[198:201], a[108:111], v[146:149], v[198:201]
    ds_read_b128 v[142:145], v3 offset:28672
    v_fma_f32 v64, v64, v154, v155
    v_mfma_f32_16x16x32_bf16 v[202:205], a[112:115], v[146:149], v[202:205]
    s_add_u32 m0, s63, 118784
    v_fma_f32 v65, v65, v154, v155
    v_mfma_f32_16x16x32_bf16 v[206:209], v[146:149], a[116:119], v[206:209]
    buffer_load_dwordx4 v96, s[28:31], s62 offen offset:0 lds
    s_waitcnt lgkmcnt(2)
    v_mfma_f32_16x16x32_bf16 v[198:201], a[120:123], v[134:137], v[198:201]
    ds_read_b128 v[146:149], v3 offset:29696
    v_fma_f32 v66, v66, v156, v157
    v_mfma_f32_16x16x32_bf16 v[202:205], a[124:127], v[134:137], v[202:205]
    s_add_u32 s62, s62, 43008
    v_fma_f32 v67, v67, v156, v157
    v_mfma_f32_16x16x32_bf16 v[206:209], v[134:137], a[128:131], v[206:209]
    v_fma_f32 v68, v68, v156, v157
    s_waitcnt lgkmcnt(2)
    v_mfma_f32_16x16x32_bf16 v[198:201], a[132:135], v[138:141], v[198:201]
    ds_read_b128 v[134:137], v3 offset:30720
    v_fma_f32 v69, v69, v156, v157
    v_mfma_f32_16x16x32_bf16 v[202:205], a[136:139], v[138:141], v[202:205]
    buffer_load_dwordx4 v96, s[28:31], s62 offen offset:1024 lds
    v_mfma_f32_16x16x32_bf16 v[206:209], v[138:141], a[140:143], v[206:209]
    s_add_u32 s62, s62, 43008
    s_waitcnt lgkmcnt(2)
    v_mfma_f32_16x16x32_bf16 v[198:201], a[144:147], v[142:145], v[198:201]
    ds_read_b128 v[138:141], v3 offset:31744
    v_mfma_f32_16x16x32_bf16 v[202:205], a[148:151], v[142:145], v[202:205]
    v_mfma_f32_16x16x32_bf16 v[206:209], v[142:145], a[152:155], v[206:209]
    buffer_load_dwordx4 v96, s[28:31], s62 offen offset:2048 lds
    s_waitcnt lgkmcnt(2)
    v_mfma_f32_16x16x32_bf16 v[198:201], a[156:159], v[146:149], v[198:201]
    s_waitcnt vmcnt(9)
    s_barrier
    ds_read_b128 v[142:145], v3 offset:34816
    v_mfma_f32_16x16x32_bf16 v[202:205], a[160:163], v[146:149], v[202:205]
    s_add_u32 s62, s62, 43008
    v_mfma_f32_16x16x32_bf16 v[206:209], v[146:149], a[164:167], v[206:209]
    s_waitcnt lgkmcnt(2)
    v_mfma_f32_16x16x32_bf16 v[198:201], a[168:171], v[134:137], v[198:201]
    ds_read_b128 v[146:149], v3 offset:35840
    v_mfma_f32_16x16x32_bf16 v[202:205], a[172:175], v[134:137], v[202:205]
    buffer_load_dwordx4 v96, s[28:31], s62 offen offset:3072 lds
    v_mfma_f32_16x16x32_bf16 v[206:209], v[134:137], a[176:179], v[206:209]
    s_add_u32 m0, s58, 51200
    s_waitcnt lgkmcnt(2)
    v_mfma_f32_16x16x32_bf16 v[198:201], a[180:183], v[138:141], v[198:201]
    ds_read_b128 v[134:137], v3 offset:36864
    v_mfma_f32_16x16x32_bf16 v[202:205], a[184:187], v[138:141], v[202:205]
    s_mov_b32 s59, 2732032
    v_mfma_f32_16x16x32_bf16 v[206:209], v[138:141], a[188:191], v[206:209]
    buffer_load_dwordx4 v6, s[20:23], s59 offen offset:0 sc1 lds
    s_waitcnt lgkmcnt(2)
    v_mfma_f32_16x16x32_bf16 v[210:213], a[24:27], v[142:145], v[210:213]
    ds_read_b128 v[138:141], v3 offset:37888
    v_mfma_f32_16x16x32_bf16 v[214:217], a[28:31], v[142:145], v[214:217]
    v_mfma_f32_16x16x32_bf16 v[218:221], v[142:145], a[32:35], v[218:221]
    s_waitcnt lgkmcnt(2)
    v_mfma_f32_16x16x32_bf16 v[210:213], a[36:39], v[146:149], v[210:213]
    ds_read_b128 v[142:145], v3 offset:38912
    v_mfma_f32_16x16x32_bf16 v[214:217], a[40:43], v[146:149], v[214:217]
    buffer_load_dwordx4 v7, s[20:23], s59 offen offset:1024 sc1 lds
    v_mfma_f32_16x16x32_bf16 v[218:221], v[146:149], a[44:47], v[218:221]
    s_waitcnt lgkmcnt(2)
    buffer_load_dwordx4 v8, s[20:23], s59 offen offset:2048 sc1 lds
    s_mov_b32 exec_hi, 0
    buffer_load_dwordx4 v9, s[20:23], s59 offen offset:3072 sc1 lds
    s_mov_b32 exec_hi, -1
    s_waitcnt vmcnt(9)
    v_cmp_eq_u32 vcc, -1, v249
    s_cbranch_vccnz L_rgs_20
L_rgb_21:
    v_max_f32_dpp v247, v248, v248 row_ror:8 row_mask:0xf bank_mask:0xf
    s_nop 1
    v_max_f32_dpp v247, v247, v247 row_ror:4 row_mask:0xf bank_mask:0xf
    s_nop 1
    v_max_f32_dpp v247, v247, v247 row_ror:2 row_mask:0xf bank_mask:0xf
    s_nop 1
    v_max_f32_dpp v247, v247, v247 row_ror:1 row_mask:0xf bank_mask:0xf
    v_mov_b32 v246, v247
    s_nop 1
    v_permlane16_swap_b32 v246, v247
    v_max_f32 v247, v246, v247
    v_cmp_eq_f32 vcc, v248, v247
    s_nop 0
    s_ff1_i32_b32 s1, vcc_lo
    s_and_b32 s1, s1, 31
    v_readlane_b32 s56, v249, s1
    v_readlane_b32 s55, v248, s1
    s_lshr_b32 s0, s56, 6
    s_lshl2_add_u32 s0, s0, s3
    s_mul_i32 s0, s0, 6144
    s_add_u32 s65, s0, 5310720
    s_cmp_lt_i32 s7, 0
    s_cselect_b32 s65, 8388608, s65
    buffer_load_dwordx4 v[102:105], v129, s[20:23], s65 offen offset:0 sc1
    buffer_load_dwordx4 v[106:109], v129, s[20:23], s65 offen offset:64 sc1
    buffer_load_dwordx4 v[110:113], v129, s[20:23], s65 offen offset:3072 sc1
    buffer_load_dwordx4 v[114:117], v129, s[20:23], s65 offen offset:3136 sc1
    v_mfma_f32_16x16x32_bf16 v[210:213], a[48:51], v[134:137], v[210:213]
    ds_read_b128 v[146:149], v3 offset:39936
    v_mfma_f32_16x16x32_bf16 v[214:217], a[52:55], v[134:137], v[214:217]
    s_lshl_b32 s0, s67, 15
    v_mfma_f32_16x16x32_bf16 v[218:221], v[134:137], a[56:59], v[218:221]
    s_waitcnt lgkmcnt(2)
    v_mfma_f32_16x16x32_bf16 v[210:213], a[60:63], v[138:141], v[210:213]
    ds_read_b128 v[134:137], v3 offset:40960
    s_waitcnt vmcnt(8)
    v_mfma_f32_16x16x32_bf16 v[214:217], a[64:67], v[138:141], v[214:217]
    buffer_load_dwordx4 v[70:73], v130, s[32:35], s0 offen offset:0
    v_mfma_f32_16x16x32_bf16 v[218:221], v[138:141], a[68:71], v[218:221]
    ds_read_b64_tr_b16 v[150:151], v124 offset:0
    s_waitcnt lgkmcnt(3)
    v_mfma_f32_16x16x32_bf16 v[210:213], a[72:75], v[142:145], v[210:213]
    ds_read_b128 v[138:141], v3 offset:41984
    v_mfma_f32_16x16x32_bf16 v[214:217], a[76:79], v[142:145], v[214:217]
    ds_read_b64_tr_b16 v[152:153], v124 offset:256
    ds_read_b64_tr_b16 v[154:155], v125 offset:0
    v_mfma_f32_16x16x32_bf16 v[218:221], v[142:145], a[80:83], v[218:221]
    buffer_load_dwordx4 v[74:77], v130, s[32:35], s0 offen offset:1024
    s_waitcnt lgkmcnt(5)
    v_mfma_f32_16x16x32_bf16 v[210:213], a[84:87], v[146:149], v[210:213]
    ds_read_b128 v[142:145], v3 offset:43008
    v_mfma_f32_16x16x32_bf16 v[214:217], a[88:91], v[146:149], v[214:217]
    ds_read_b64_tr_b16 v[156:157], v125 offset:256
    ds_read_b64_tr_b16 v[158:159], v124 offset:32768
    v_mfma_f32_16x16x32_bf16 v[218:221], v[146:149], a[92:95], v[218:221]
    ds_read_b64_tr_b16 v[160:161], v124 offset:33024
    s_waitcnt lgkmcnt(8)
    v_mfma_f32_16x16x32_bf16 v[210:213], a[96:99], v[134:137], v[210:213]
    ds_read_b128 v[146:149], v3 offset:44032
    v_mfma_f32_16x16x32_bf16 v[214:217], a[100:103], v[134:137], v[214:217]
    buffer_load_dwordx4 v[78:81], v130, s[32:35], s0 offen offset:2048
    v_mfma_f32_16x16x32_bf16 v[218:221], v[134:137], a[104:107], v[218:221]
    ds_read_b64_tr_b16 v[162:163], v125 offset:32768
    s_waitcnt lgkmcnt(8)
    v_mfma_f32_16x16x32_bf16 v[210:213], a[108:111], v[138:141], v[210:213]
    ds_read_b128 v[134:137], v3 offset:45056
    v_mfma_f32_16x16x32_bf16 v[214:217], a[112:115], v[138:141], v[214:217]
    ds_read_b64_tr_b16 v[164:165], v125 offset:33024
    ds_read_b64_tr_b16 v[166:167], v124 offset:2048
    v_mfma_f32_16x16x32_bf16 v[218:221], v[138:141], a[116:119], v[218:221]
    buffer_load_dwordx4 v[82:85], v130, s[32:35], s0 offen offset:3072
    s_waitcnt lgkmcnt(8)
    v_mfma_f32_16x16x32_bf16 v[210:213], a[120:123], v[142:145], v[210:213]
    ds_read_b128 v[138:141], v3 offset:46080
    v_mfma_f32_16x16x32_bf16 v[214:217], a[124:127], v[142:145], v[214:217]
    s_lshl_b32 s1, s67, 15
    s_add_u32 s1, s1, 4096
    v_mfma_f32_16x16x32_bf16 v[218:221], v[142:145], a[128:131], v[218:221]
    ds_read_b64_tr_b16 v[168:169], v124 offset:2304
    s_waitcnt lgkmcnt(6)
    v_mfma_f32_16x16x32_bf16 v[210:213], a[132:135], v[146:149], v[210:213]
    ds_read_b128 v[142:145], v3 offset:47104
    v_mfma_f32_16x16x32_bf16 v[214:217], a[136:139], v[146:149], v[214:217]
    buffer_load_dwordx4 v[86:89], v130, s[32:35], s1 offen offset:0
    v_mfma_f32_16x16x32_bf16 v[218:221], v[146:149], a[140:143], v[218:221]
    ds_read_b64_tr_b16 v[170:171], v125 offset:2048
    s_waitcnt lgkmcnt(6)
    v_mfma_f32_16x16x32_bf16 v[210:213], a[144:147], v[134:137], v[210:213]
    ds_read_b128 v[146:149], v3 offset:48128
    v_mfma_f32_16x16x32_bf16 v[214:217], a[148:151], v[134:137], v[214:217]
    ds_read_b64_tr_b16 v[172:173], v125 offset:2304
    ds_read_b64_tr_b16 v[174:175], v124 offset:34816
    v_mfma_f32_16x16x32_bf16 v[218:221], v[134:137], a[152:155], v[218:221]
    buffer_load_dwordx4 v[90:93], v130, s[32:35], s1 offen offset:1024
    s_waitcnt lgkmcnt(6)
    v_mfma_f32_16x16x32_bf16 v[210:213], a[156:159], v[138:141], v[210:213]
    s_waitcnt vmcnt(10)
    s_barrier
    ds_read_b128 v[134:137], v3 offset:51200
    v_mfma_f32_16x16x32_bf16 v[214:217], a[160:163], v[138:141], v[214:217]
    ds_read_b64_tr_b16 v[176:177], v124 offset:35072
    ds_read_b64_tr_b16 v[178:179], v125 offset:34816
    v_mfma_f32_16x16x32_bf16 v[218:221], v[138:141], a[164:167], v[218:221]
    ds_read_b64_tr_b16 v[180:181], v125 offset:35072
    s_waitcnt lgkmcnt(8)
    buffer_load_dwordx4 v[94:97], v130, s[32:35], s1 offen offset:2048
    buffer_load_dwordx4 v[98:101], v130, s[32:35], s1 offen offset:3072
    s_cmp_lt_i32 s7, 0
    s_cbranch_scc1 L_h4_23
    s_waitcnt vmcnt(8) lgkmcnt(0)
    s_mov_b32 s57, 0
L_ffb_24:
    v_mfma_f32_16x16x32_bf16 v[186:189], v[150:153], v[102:105], 0
    ds_read_b64_tr_b16 v[150:151], v124 offset:4096
    ds_read_b64_tr_b16 v[152:153], v124 offset:4352
    v_mfma_f32_16x16x32_bf16 v[190:193], v[154:157], v[102:105], 0
    ds_read_b64_tr_b16 v[154:155], v125 offset:4096
    ds_read_b64_tr_b16 v[156:157], v125 offset:4352
    v_mfma_f32_16x16x32_bf16 v[194:197], v[158:161], v[102:105], 0
    ds_read_b64_tr_b16 v[158:159], v124 offset:36864
    ds_read_b64_tr_b16 v[160:161], v124 offset:37120
    v_mfma_f32_16x16x32_bf16 v[182:185], v[162:165], v[102:105], 0
    ds_read_b64_tr_b16 v[162:163], v125 offset:36864
    ds_read_b64_tr_b16 v[164:165], v125 offset:37120
    v_mfma_f32_16x16x32_bf16 v[186:189], v[166:169], v[106:109], v[186:189]
    ds_read_b64_tr_b16 v[166:167], v124 offset:6144
    ds_read_b64_tr_b16 v[168:169], v124 offset:6400
    v_mfma_f32_16x16x32_bf16 v[190:193], v[170:173], v[106:109], v[190:193]
    ds_read_b64_tr_b16 v[170:171], v125 offset:6144
    ds_read_b64_tr_b16 v[172:173], v125 offset:6400
    v_mfma_f32_16x16x32_bf16 v[194:197], v[174:177], v[106:109], v[194:197]
    ds_read_b64_tr_b16 v[174:175], v124 offset:38912
    ds_read_b64_tr_b16 v[176:177], v124 offset:39168
    v_mfma_f32_16x16x32_bf16 v[182:185], v[178:181], v[106:109], v[182:185]
    ds_read_b64_tr_b16 v[178:179], v125 offset:38912
    ds_read_b64_tr_b16 v[180:181], v125 offset:39168
    s_waitcnt lgkmcnt(14)
    v_mfma_f32_16x16x32_bf16 v[186:189], v[150:153], v[110:113], v[186:189]
    s_waitcnt lgkmcnt(12)
    v_mfma_f32_16x16x32_bf16 v[190:193], v[154:157], v[110:113], v[190:193]
    s_waitcnt lgkmcnt(10)
    v_mfma_f32_16x16x32_bf16 v[194:197], v[158:161], v[110:113], v[194:197]
    s_waitcnt lgkmcnt(8)
    v_mfma_f32_16x16x32_bf16 v[182:185], v[162:165], v[110:113], v[182:185]
    s_waitcnt lgkmcnt(6)
    v_mfma_f32_16x16x32_bf16 v[186:189], v[166:169], v[114:117], v[186:189]
    s_waitcnt lgkmcnt(4)
    v_mfma_f32_16x16x32_bf16 v[190:193], v[170:173], v[114:117], v[190:193]
    s_waitcnt lgkmcnt(2)
    v_mfma_f32_16x16x32_bf16 v[194:197], v[174:177], v[114:117], v[194:197]
    s_waitcnt lgkmcnt(0)
    v_mfma_f32_16x16x32_bf16 v[182:185], v[178:181], v[114:117], v[182:185]
    s_mov_b32 exec_lo, 0x10001
    s_mov_b32 exec_hi, 0x10001
    ds_write_b128 v126, v[186:189] offset:0
    s_nop 0
    ds_write_b128 v126, v[190:193] offset:64
    s_nop 0
    ds_write_b128 v126, v[194:197] offset:128
    s_nop 0
    ds_write_b128 v126, v[182:185] offset:192
    s_mov_b64 exec, -1
    s_add_u32 s57, s57, 1
    s_cmp_lt_u32 s57, 2000
    s_waitcnt lgkmcnt(0)
    s_barrier
    ds_read2st64_b32 v[250:251], v127 offset0:0 offset1:1
    ds_read2st64_b32 v[252:253], v127 offset0:2 offset1:3
    s_waitcnt lgkmcnt(0)
    v_add_f32 v250, v250, v251
    v_add_f32 v252, v252, v253
    v_add_f32 v250, v250, v252
    v_mul_f32 v252, 0xbfb8aa3b, v250
    v_cmp_u_f32 vcc, v250, v250
    v_exp_f32 v252, v252
    v_mul_f32_dpp v250, v250, v250 row_ror:8 row_mask:0xf bank_mask:0xf
    v_add_f32 v252, 1.0, v252
    v_rcp_f32 v252, v252
    s_cselect_b64 vcc, vcc, 0
    v_mul_f32 v250, v250, v252
    v_cvt_pk_bf16_f32 v250, v250, v250
    s_cbranch_vccnz L_ffr_25
    s_waitcnt vmcnt(0)
    v_and_b32_dpp v102, v250, v118 row_newbcast:0 row_mask:0xf bank_mask:0xf
    v_and_b32_dpp v103, v250, v119 row_newbcast:0 row_mask:0xf bank_mask:0xf
    v_and_b32_dpp v104, v250, v120 row_newbcast:0 row_mask:0xf bank_mask:0xf
    v_and_b32_dpp v105, v250, v121 row_newbcast:0 row_mask:0xf bank_mask:0xf
    s_add_u32 m0, s58, 67584
    s_mov_b32 s59, 2748416
    buffer_load_dwordx4 v6, s[20:23], s59 offen offset:0 sc1 lds
    v_and_b32_dpp v106, v250, v118 row_newbcast:1 row_mask:0xf bank_mask:0xf
    v_and_b32_dpp v107, v250, v119 row_newbcast:1 row_mask:0xf bank_mask:0xf
    v_and_b32_dpp v108, v250, v120 row_newbcast:1 row_mask:0xf bank_mask:0xf
    v_and_b32_dpp v109, v250, v121 row_newbcast:1 row_mask:0xf bank_mask:0xf
    v_mfma_f32_16x16x32_bf16 v[186:189], v[102:105], v[70:73], 0
    v_and_b32_dpp v110, v250, v118 row_newbcast:2 row_mask:0xf bank_mask:0xf
    v_and_b32_dpp v111, v250, v119 row_newbcast:2 row_mask:0xf bank_mask:0xf
    v_and_b32_dpp v112, v250, v120 row_newbcast:2 row_mask:0xf bank_mask:0xf
    v_and_b32_dpp v113, v250, v121 row_newbcast:2 row_mask:0xf bank_mask:0xf
    v_mfma_f32_16x16x32_bf16 v[186:189], v[106:109], v[74:77], v[186:189]
    v_and_b32_dpp v114, v250, v118 row_newbcast:3 row_mask:0xf bank_mask:0xf
    v_and_b32_dpp v115, v250, v119 row_newbcast:3 row_mask:0xf bank_mask:0xf
    v_and_b32_dpp v116, v250, v120 row_newbcast:3 row_mask:0xf bank_mask:0xf
    v_and_b32_dpp v117, v250, v121 row_newbcast:3 row_mask:0xf bank_mask:0xf
    v_mfma_f32_16x16x32_bf16 v[186:189], v[110:113], v[78:81], v[186:189]
    buffer_load_dwordx4 v7, s[20:23], s59 offen offset:1024 sc1 lds
    v_and_b32_dpp v102, v250, v118 row_newbcast:4 row_mask:0xf bank_mask:0xf
    v_and_b32_dpp v103, v250, v119 row_newbcast:4 row_mask:0xf bank_mask:0xf
    v_and_b32_dpp v104, v250, v120 row_newbcast:4 row_mask:0xf bank_mask:0xf
    v_and_b32_dpp v105, v250, v121 row_newbcast:4 row_mask:0xf bank_mask:0xf
    v_mfma_f32_16x16x32_bf16 v[186:189], v[114:117], v[82:85], v[186:189]
    v_and_b32_dpp v106, v250, v118 row_newbcast:5 row_mask:0xf bank_mask:0xf
    v_and_b32_dpp v107, v250, v119 row_newbcast:5 row_mask:0xf bank_mask:0xf
    v_and_b32_dpp v108, v250, v120 row_newbcast:5 row_mask:0xf bank_mask:0xf
    v_and_b32_dpp v109, v250, v121 row_newbcast:5 row_mask:0xf bank_mask:0xf
    v_mfma_f32_16x16x32_bf16 v[186:189], v[102:105], v[86:89], v[186:189]
    v_and_b32_dpp v110, v250, v118 row_newbcast:6 row_mask:0xf bank_mask:0xf
    v_and_b32_dpp v111, v250, v119 row_newbcast:6 row_mask:0xf bank_mask:0xf
    v_and_b32_dpp v112, v250, v120 row_newbcast:6 row_mask:0xf bank_mask:0xf
    v_and_b32_dpp v113, v250, v121 row_newbcast:6 row_mask:0xf bank_mask:0xf
    v_mfma_f32_16x16x32_bf16 v[186:189], v[106:109], v[90:93], v[186:189]
    buffer_load_dwordx4 v8, s[20:23], s59 offen offset:2048 sc1 lds
    v_and_b32_dpp v114, v250, v118 row_newbcast:7 row_mask:0xf bank_mask:0xf
    v_and_b32_dpp v115, v250, v119 row_newbcast:7 row_mask:0xf bank_mask:0xf
    v_and_b32_dpp v116, v250, v120 row_newbcast:7 row_mask:0xf bank_mask:0xf
    v_and_b32_dpp v117, v250, v121 row_newbcast:7 row_mask:0xf bank_mask:0xf
    v_mfma_f32_16x16x32_bf16 v[186:189], v[110:113], v[94:97], v[186:189]
    s_nop 0
    v_mfma_f32_16x16x32_bf16 v[186:189], v[114:117], v[98:101], v[186:189]
    s_mov_b32 exec_hi, 0
    buffer_load_dwordx4 v9, s[20:23], s59 offen offset:3072 sc1 lds
    s_mov_b32 exec_hi, -1
    s_nop 4
    v_cvt_pk_bf16_f32 v250, v186, v187
    v_cvt_pk_bf16_f32 v251, v188, v189
    s_branch L_h2_22
L_h4_23:
    s_add_u32 m0, s58, 67584
    s_mov_b32 s59, 2748416
    buffer_load_dwordx4 v6, s[20:23], s59 offen offset:0 sc1 lds
    buffer_load_dwordx4 v7, s[20:23], s59 offen offset:1024 sc1 lds
    buffer_load_dwordx4 v8, s[20:23], s59 offen offset:2048 sc1 lds
    s_mov_b32 exec_hi, 0
    buffer_load_dwordx4 v9, s[20:23], s59 offen offset:3072 sc1 lds
    s_mov_b32 exec_hi, -1
L_h2_22:
    s_mov_b32 exec_hi, 0
    buffer_store_dwordx2 v[250:251], v128, s[20:23], s66 offen sc1
    s_mov_b64 exec, -1
    v_mov_b32 v252, -1
    v_mov_b32 v253, -1
    s_add_u32 s66, s66, 49152
    s_mov_b32 exec_hi, 0
    buffer_store_dwordx2 v[252:253], v128, s[20:23], s66 offen sc1
    s_mov_b64 exec, -1
    s_waitcnt vmcnt(14)
    v_mfma_f32_16x16x32_bf16 v[210:213], a[168:171], v[142:145], v[210:213]
    ds_read_b128 v[138:141], v3 offset:52224
    v_mfma_f32_16x16x32_bf16 v[214:217], a[172:175], v[142:145], v[214:217]
    s_add_u32 m0, s58, 2048
    s_mov_b32 s59, 2682880
    v_mfma_f32_16x16x32_bf16 v[218:221], v[142:145], a[176:179], v[218:221]
    ds_read_b64 v[174:175], v12 offset:0
    s_waitcnt lgkmcnt(8)
    v_mfma_f32_16x16x32_bf16 v[210:213], a[180:183], v[146:149], v[210:213]
    ds_read_b128 v[142:145], v3 offset:53248
    v_mfma_f32_16x16x32_bf16 v[214:217], a[184:187], v[146:149], v[214:217]
    buffer_load_dwordx4 v6, s[20:23], s59 offen offset:0 sc1 lds
    v_mfma_f32_16x16x32_bf16 v[218:221], v[146:149], a[188:191], v[218:221]
    ds_read_b64 v[176:177], v12 offset:256
    s_waitcnt lgkmcnt(7)
    v_mfma_f32_16x16x32_bf16 v[222:225], a[24:27], v[134:137], v[222:225]
    ds_read_b128 v[146:149], v3 offset:54272
    v_mfma_f32_16x16x32_bf16 v[226:229], a[28:31], v[134:137], v[226:229]
    ds_read_b64 v[178:179], v12 offset:512
    ds_read_b64 v[180:181], v12 offset:768
    v_mfma_f32_16x16x32_bf16 v[230:233], v[134:137], a[32:35], v[230:233]
    buffer_load_dwordx4 v7, s[20:23], s59 offen offset:1024 sc1 lds
    s_waitcnt lgkmcnt(6)
    v_mfma_f32_16x16x32_bf16 v[222:225], a[36:39], v[138:141], v[222:225]
    ds_read_b128 v[134:137], v3 offset:55296
    v_mfma_f32_16x16x32_bf16 v[226:229], a[40:43], v[138:141], v[226:229]
    ds_read_b64 v[182:183], v12 offset:1024
    ds_read_b128 v[166:169], v13 offset:64
    v_mfma_f32_16x16x32_bf16 v[230:233], v[138:141], a[44:47], v[230:233]
    ds_read_b128 v[170:173], v13 offset:384
    s_waitcnt lgkmcnt(8)
    v_mfma_f32_16x16x32_bf16 v[222:225], a[48:51], v[142:145], v[222:225]
    ds_read_b128 v[138:141], v3 offset:56320
    v_mfma_f32_16x16x32_bf16 v[226:229], a[52:55], v[142:145], v[226:229]
    buffer_load_dwordx4 v8, s[20:23], s59 offen offset:2048 sc1 lds
    v_mfma_f32_16x16x32_bf16 v[230:233], v[142:145], a[56:59], v[230:233]
    ds_read_b128 v[158:161], v13 offset:128
    s_waitcnt lgkmcnt(8)
    v_mfma_f32_16x16x32_bf16 v[222:225], a[60:63], v[146:149], v[222:225]
    ds_read_b128 v[142:145], v3 offset:57344
    v_mfma_f32_16x16x32_bf16 v[226:229], a[64:67], v[146:149], v[226:229]
    ds_read_b128 v[162:165], v13 offset:448
    v_mov_b32 v246, 0xf149f2ca
    v_mfma_f32_16x16x32_bf16 v[230:233], v[146:149], a[68:71], v[230:233]
    s_mov_b32 exec_hi, 0
    buffer_load_dwordx4 v9, s[20:23], s59 offen offset:3072 sc1 lds
    s_mov_b32 exec_hi, -1
    s_waitcnt lgkmcnt(7)
    v_mfma_f32_16x16x32_bf16 v[222:225], a[72:75], v[134:137], v[222:225]
    ds_read_b128 v[146:149], v3 offset:58368
    v_cndmask_b32 v250, v24, v246, s[50:51]
    v_mfma_f32_16x16x32_bf16 v[226:229], a[76:79], v[134:137], v[226:229]
    v_cndmask_b32 v251, v25, v246, s[50:51]
    v_cndmask_b32 v252, v26, v246, s[50:51]
    v_mfma_f32_16x16x32_bf16 v[230:233], v[134:137], a[80:83], v[230:233]
    v_cndmask_b32 v253, v27, v246, s[50:51]
    s_waitcnt lgkmcnt(4)
    v_mfma_f32_16x16x32_bf16 v[222:225], a[84:87], v[138:141], v[222:225]
    ds_read_b128 v[134:137], v3 offset:59392
    v_fma_f32 v198, v28, v176, v198
    v_mfma_f32_16x16x32_bf16 v[226:229], a[88:91], v[138:141], v[226:229]
    v_fma_f32 v202, v32, v176, v202
    v_fma_f32 v206, v36, v166, v206
    v_mfma_f32_16x16x32_bf16 v[230:233], v[138:141], a[92:95], v[230:233]
    v_mul_f32 v202, v202, v177
    s_waitcnt lgkmcnt(3)
    v_mfma_f32_16x16x32_bf16 v[222:225], a[96:99], v[142:145], v[222:225]
    ds_read_b128 v[138:141], v3 offset:60416
    v_mul_f32 v206, v206, v170
    v_mfma_f32_16x16x32_bf16 v[226:229], a[100:103], v[142:145], v[226:229]
    v_fma_f32 v199, v29, v176, v199
    v_fma_f32 v203, v33, v176, v203
    v_mfma_f32_16x16x32_bf16 v[230:233], v[142:145], a[104:107], v[230:233]
    v_fma_f32 v207, v36, v167, v207
    s_waitcnt lgkmcnt(2)
    v_mfma_f32_16x16x32_bf16 v[222:225], a[108:111], v[146:149], v[222:225]
    ds_read_b128 v[142:145], v3 offset:61440
    v_mul_f32 v203, v203, v177
    v_mfma_f32_16x16x32_bf16 v[226:229], a[112:115], v[146:149], v[226:229]
    v_mul_f32 v207, v207, v171
    v_fma_f32 v200, v30, v176, v200
    v_mfma_f32_16x16x32_bf16 v[230:233], v[146:149], a[116:119], v[230:233]
    v_fma_f32 v204, v34, v176, v204
    s_waitcnt lgkmcnt(2)
    v_mfma_f32_16x16x32_bf16 v[222:225], a[120:123], v[134:137], v[222:225]
    ds_read_b128 v[146:149], v3 offset:62464
    v_fma_f32 v208, v36, v168, v208
    v_mfma_f32_16x16x32_bf16 v[226:229], a[124:127], v[134:137], v[226:229]
    v_mul_f32 v204, v204, v177
    v_mul_f32 v208, v208, v172
    v_mfma_f32_16x16x32_bf16 v[230:233], v[134:137], a[128:131], v[230:233]
    v_fma_f32 v201, v31, v176, v201
    s_waitcnt lgkmcnt(2)
    v_mfma_f32_16x16x32_bf16 v[222:225], a[132:135], v[138:141], v[222:225]
    ds_read_b128 v[134:137], v3 offset:63488
    v_fma_f32 v205, v35, v176, v205
    v_mfma_f32_16x16x32_bf16 v[226:229], a[136:139], v[138:141], v[226:229]
    v_fma_f32 v209, v36, v169, v209
    v_mul_f32 v205, v205, v177
    v_mfma_f32_16x16x32_bf16 v[230:233], v[138:141], a[140:143], v[230:233]
    v_mul_f32 v209, v209, v173
    s_waitcnt lgkmcnt(2)
    v_mfma_f32_16x16x32_bf16 v[222:225], a[144:147], v[142:145], v[222:225]
    ds_read_b128 v[138:141], v3 offset:64512
    v_cvt_pk_bf16_f32 v104, v198, v199
    v_mfma_f32_16x16x32_bf16 v[226:229], a[148:151], v[142:145], v[226:229]
    v_cvt_pk_bf16_f32 v105, v200, v201
    v_cvt_pk_bf16_f32 v114, v202, v203
    v_mfma_f32_16x16x32_bf16 v[230:233], v[142:145], a[152:155], v[230:233]
    v_cvt_pk_bf16_f32 v115, v204, v205
    s_waitcnt lgkmcnt(2)
    v_mfma_f32_16x16x32_bf16 v[222:225], a[156:159], v[146:149], v[222:225]
    s_waitcnt vmcnt(6)
    s_barrier
    ds_read_b128 v[142:145], v4 offset:2048
    v_cvt_pk_bf16_f32 v126, v206, v207
    v_mfma_f32_16x16x32_bf16 v[226:229], a[160:163], v[146:149], v[226:229]
    v_cvt_pk_bf16_f32 v127, v208, v209
    v_mul_f32 v177, 0x3eb8aa3b, v177
    v_mfma_f32_16x16x32_bf16 v[230:233], v[146:149], a[164:167], v[230:233]
    ds_read_b128 v[166:169], v13 offset:192
    s_waitcnt lgkmcnt(3)
    v_mfma_f32_16x16x32_bf16 v[222:225], a[168:171], v[134:137], v[222:225]
    ds_read_b128 v[146:149], v4 offset:3072
    v_mfma_f32_16x16x32_bf16 v[226:229], a[172:175], v[134:137], v[226:229]
    ds_read_b128 v[170:173], v13 offset:512
    v_mfma_f32_16x16x32_bf16 v[230:233], v[134:137], a[176:179], v[230:233]
    v_fma_f32 v210, v28, v178, v210
    s_waitcnt lgkmcnt(4)
    v_mfma_f32_16x16x32_bf16 v[222:225], a[180:183], v[138:141], v[222:225]
    ds_read_b128 v[134:137], v4 offset:4096
    v_fma_f32 v214, v32, v178, v214
    v_mfma_f32_16x16x32_bf16 v[226:229], a[184:187], v[138:141], v[226:229]
    v_fma_f32 v218, v36, v158, v218
    v_mul_f32 v214, v214, v179
    v_mfma_f32_16x16x32_bf16 v[230:233], v[138:141], a[188:191], v[230:233]
    v_mul_f32 v218, v218, v162
    s_waitcnt lgkmcnt(4)
    v_mfma_f32_16x16x32_bf16 v[234:237], a[24:27], v[142:145], v[234:237]
    ds_read_b128 v[138:141], v4 offset:5120
    v_fma_f32 v211, v29, v178, v211
    v_mfma_f32_16x16x32_bf16 v[238:241], a[28:31], v[142:145], v[238:241]
    v_fma_f32 v215, v33, v178, v215
    v_fma_f32 v219, v36, v159, v219
    v_mfma_f32_16x16x32_bf16 v[242:245], v[142:145], a[32:35], v[242:245]
    v_mul_f32 v215, v215, v179
    s_waitcnt lgkmcnt(3)
    v_mfma_f32_16x16x32_bf16 v[234:237], a[36:39], v[146:149], v[234:237]
    ds_read_b128 v[142:145], v4 offset:6144
    v_mul_f32 v219, v219, v163
    v_mfma_f32_16x16x32_bf16 v[238:241], a[40:43], v[146:149], v[238:241]
    v_fma_f32 v212, v30, v178, v212
    v_fma_f32 v216, v34, v178, v216
    v_mfma_f32_16x16x32_bf16 v[242:245], v[146:149], a[44:47], v[242:245]
    v_fma_f32 v220, v36, v160, v220
    s_waitcnt lgkmcnt(2)
    v_mfma_f32_16x16x32_bf16 v[234:237], a[48:51], v[134:137], v[234:237]
    ds_read_b128 v[146:149], v4 offset:7168
    v_mul_f32 v216, v216, v179
    v_mfma_f32_16x16x32_bf16 v[238:241], a[52:55], v[134:137], v[238:241]
    v_mul_f32 v220, v220, v164
    v_fma_f32 v213, v31, v178, v213
    v_mfma_f32_16x16x32_bf16 v[242:245], v[134:137], a[56:59], v[242:245]
    v_fma_f32 v217, v35, v178, v217
    s_waitcnt lgkmcnt(2)
    v_mfma_f32_16x16x32_bf16 v[234:237], a[60:63], v[138:141], v[234:237]
    ds_read_b128 v[134:137], v4 offset:8192
    v_fma_f32 v221, v36, v161, v221
    v_mfma_f32_16x16x32_bf16 v[238:241], a[64:67], v[138:141], v[238:241]
    v_mul_f32 v217, v217, v179
    v_mul_f32 v221, v221, v165
    v_mfma_f32_16x16x32_bf16 v[242:245], v[138:141], a[68:71], v[242:245]
    v_cvt_pk_bf16_f32 v106, v210, v211
    s_waitcnt lgkmcnt(2)
    v_mfma_f32_16x16x32_bf16 v[234:237], a[72:75], v[142:145], v[234:237]
    ds_read_b128 v[138:141], v4 offset:9216
    v_cvt_pk_bf16_f32 v107, v212, v213
    v_mfma_f32_16x16x32_bf16 v[238:241], a[76:79], v[142:145], v[238:241]
    v_cvt_pk_bf16_f32 v116, v214, v215
    v_cvt_pk_bf16_f32 v117, v216, v217
    v_mfma_f32_16x16x32_bf16 v[242:245], v[142:145], a[80:83], v[242:245]
    v_cvt_pk_bf16_f32 v128, v218, v219
    s_waitcnt lgkmcnt(2)
    v_mfma_f32_16x16x32_bf16 v[234:237], a[84:87], v[146:149], v[234:237]
    ds_read_b128 v[142:145], v4 offset:10240
    v_cvt_pk_bf16_f32 v129, v220, v221
    v_mfma_f32_16x16x32_bf16 v[238:241], a[88:91], v[146:149], v[238:241]
    v_mul_f32 v179, 0x3eb8aa3b, v179
    ds_read_b128 v[158:161], v13 offset:256
    v_mfma_f32_16x16x32_bf16 v[242:245], v[146:149], a[92:95], v[242:245]
    ds_read_b128 v[162:165], v13 offset:576
    s_waitcnt lgkmcnt(4)
    v_mfma_f32_16x16x32_bf16 v[234:237], a[96:99], v[134:137], v[234:237]
    ds_read_b128 v[146:149], v4 offset:11264
    v_fma_f32 v222, v28, v180, v222
    v_mfma_f32_16x16x32_bf16 v[238:241], a[100:103], v[134:137], v[238:241]
    v_fma_f32 v226, v32, v180, v226
    v_fma_f32 v230, v36, v166, v230
    v_mfma_f32_16x16x32_bf16 v[242:245], v[134:137], a[104:107], v[242:245]
    v_mul_f32 v226, v226, v181
    s_waitcnt lgkmcnt(4)
    v_mfma_f32_16x16x32_bf16 v[234:237], a[108:111], v[138:141], v[234:237]
    ds_read_b128 v[134:137], v4 offset:12288
    v_mul_f32 v230, v230, v170
    v_mfma_f32_16x16x32_bf16 v[238:241], a[112:115], v[138:141], v[238:241]
    v_fma_f32 v223, v29, v180, v223
    v_fma_f32 v227, v33, v180, v227
    v_mfma_f32_16x16x32_bf16 v[242:245], v[138:141], a[116:119], v[242:245]
    v_fma_f32 v231, v36, v167, v231
    s_waitcnt lgkmcnt(4)
    v_mfma_f32_16x16x32_bf16 v[234:237], a[120:123], v[142:145], v[234:237]
    ds_read_b128 v[138:141], v4 offset:13312
    v_mul_f32 v227, v227, v181
    v_mfma_f32_16x16x32_bf16 v[238:241], a[124:127], v[142:145], v[238:241]
    v_mul_f32 v231, v231, v171
    v_fma_f32 v224, v30, v180, v224
    v_mfma_f32_16x16x32_bf16 v[242:245], v[142:145], a[128:131], v[242:245]
    v_fma_f32 v228, v34, v180, v228
    s_waitcnt lgkmcnt(2)
    v_mfma_f32_16x16x32_bf16 v[234:237], a[132:135], v[146:149], v[234:237]
    ds_read_b128 v[142:145], v4 offset:14336
    v_fma_f32 v232, v36, v168, v232
    v_mfma_f32_16x16x32_bf16 v[238:241], a[136:139], v[146:149], v[238:241]
    v_mul_f32 v228, v228, v181
    v_mul_f32 v232, v232, v172
    v_mfma_f32_16x16x32_bf16 v[242:245], v[146:149], a[140:143], v[242:245]
    v_fma_f32 v225, v31, v180, v225
    s_waitcnt lgkmcnt(2)
    v_mfma_f32_16x16x32_bf16 v[234:237], a[144:147], v[134:137], v[234:237]
    ds_read_b128 v[146:149], v4 offset:15360
    v_fma_f32 v229, v35, v180, v229
    v_mfma_f32_16x16x32_bf16 v[238:241], a[148:151], v[134:137], v[238:241]
    v_fma_f32 v233, v36, v169, v233
    v_mul_f32 v229, v229, v181
    v_mfma_f32_16x16x32_bf16 v[242:245], v[134:137], a[152:155], v[242:245]
    v_mul_f32 v233, v233, v173
    s_waitcnt lgkmcnt(2)
    v_mfma_f32_16x16x32_bf16 v[234:237], a[156:159], v[138:141], v[234:237]
    v_cvt_pk_bf16_f32 v108, v222, v223
    v_cvt_pk_bf16_f32 v109, v224, v225
    v_mfma_f32_16x16x32_bf16 v[238:241], a[160:163], v[138:141], v[238:241]
    v_cvt_pk_bf16_f32 v118, v226, v227
    v_cvt_pk_bf16_f32 v119, v228, v229
    v_mfma_f32_16x16x32_bf16 v[242:245], v[138:141], a[164:167], v[242:245]
    v_cvt_pk_bf16_f32 v130, v230, v231
    s_waitcnt lgkmcnt(1)
    v_mfma_f32_16x16x32_bf16 v[234:237], a[168:171], v[142:145], v[234:237]
    v_cvt_pk_bf16_f32 v131, v232, v233
    v_mul_f32 v181, 0x3eb8aa3b, v181
    v_mfma_f32_16x16x32_bf16 v[238:241], a[172:175], v[142:145], v[238:241]
    ds_read_b128 v[166:169], v13 offset:0
    ds_read_b128 v[170:173], v13 offset:320
    v_mfma_f32_16x16x32_bf16 v[242:245], v[142:145], a[176:179], v[242:245]
    s_waitcnt lgkmcnt(2)
    v_mfma_f32_16x16x32_bf16 v[234:237], a[180:183], v[146:149], v[234:237]
    v_mfma_f32_16x16x32_bf16 v[238:241], a[184:187], v[146:149], v[238:241]
    v_mfma_f32_16x16x32_bf16 v[242:245], v[146:149], a[188:191], v[242:245]
    s_waitcnt vmcnt(0)
    s_barrier
    s_cmp_eq_u32 s54, 0
    s_cbranch_scc1 L_unk_27
L_known_26:
    s_lshr_b32 s0, s56, 6
    s_and_b32 s1, s56, 63
    s_lshr_b32 s60, s1, 4
    s_add_u32 s60, s60, 1
    s_and_b32 s61, s1, 15
    s_cmp_eq_u32 s0, s5
    s_cbranch_scc1 L_own_28
    s_add_u32 s0, s0, 1
    s_cmp_eq_u32 s0, s5
    s_cbranch_scc0 L_plain0
    s_and_b32 s0, s5, 15
    s_cbranch_scc0 L_plain0
    s_cmp_ge_u32 s1, 57
    s_cbranch_scc0 L_plain0
    s_mov_b32 s60, 0
L_own_28:
    s_mov_b32 s54, 2
    s_waitcnt lgkmcnt(0)
    v_pk_fma_f32 v[234:235], v[28:29], v[182:183], v[234:235] op_sel_hi:[1,0,1]
    v_pk_fma_f32 v[238:239], v[32:33], v[182:183], v[238:239] op_sel_hi:[1,0,1]
    v_pk_fma_f32 v[242:243], v[36:37], v[158:159], v[242:243] op_sel_hi:[0,1,1]
    v_pk_fma_f32 v[236:237], v[30:31], v[182:183], v[236:237] op_sel_hi:[1,0,1]
    v_pk_fma_f32 v[240:241], v[34:35], v[182:183], v[240:241] op_sel_hi:[1,0,1]
    v_pk_fma_f32 v[244:245], v[36:37], v[160:161], v[244:245] op_sel_hi:[0,1,1]
    v_pk_mul_f32 v[238:239], v[238:239], v[182:183] op_sel:[0,1] op_sel_hi:[1,1]
    v_pk_mul_f32 v[242:243], v[242:243], v[162:163]
    v_pk_mul_f32 v[240:241], v[240:241], v[182:183] op_sel:[0,1] op_sel_hi:[1,1]
    v_pk_mul_f32 v[244:245], v[244:245], v[164:165]
    v_cvt_pk_bf16_f32 v110, v234, v235
    v_cvt_pk_bf16_f32 v111, v236, v237
    v_cvt_pk_bf16_f32 v120, v238, v239
    v_cvt_pk_bf16_f32 v121, v240, v241
    v_cvt_pk_bf16_f32 v132, v242, v243
    v_cvt_pk_bf16_f32 v133, v244, v245
    v_mul_f32 v183, 0x3eb8aa3b, v183
    s_sub_u32 s62, s4, s3
    s_and_b32 s0, s62, 3
    s_cmp_eq_u32 s0, 1
    s_cselect_b32 s0, 1, 0
    s_cmp_eq_u32 s0, s3
    s_cbranch_scc0 L_st2_29
    s_lshl_b32 s0, s60, 11
    s_add_u32 s0, s0, 147456
    s_lshl_b32 s1, s60, 14
    s_add_u32 s1, s1, 14336
    s_cmp_eq_u32 s3, 0
    s_cselect_b32 s64, s0, s1
    v_and_b32 v247, 7, v1
    v_lshrrev_b32 v246, 3, v0
    v_lshlrev_b32 v246, 10, v246
    v_lshl_add_u32 v246, v247, 4, v246
    v_mov_b32 v218, 0
    v_mov_b32 v219, 0
    v_mov_b32 v220, 0
    v_mov_b32 v221, 0
    s_lshl_b32 s0, s62, 7
    s_add_u32 s0, s0, 6225920
    buffer_load_dwordx4 v[198:201], v246, s[20:23], s0 offen sc1
    s_add_u32 s0, s0, 8192
    buffer_load_dwordx4 v[202:205], v246, s[20:23], s0 offen sc1
    s_add_u32 s0, s0, 8192
    buffer_load_dwordx4 v[206:209], v246, s[20:23], s0 offen sc1
    s_add_u32 s0, s0, 8192
    buffer_load_dwordx4 v[210:213], v246, s[20:23], s0 offen sc1
    s_add_u32 s0, s0, 8192
    buffer_load_dwordx4 v[214:217], v246, s[20:23], s0 offen sc1
    s_add_u32 s0, s0, 8192
    s_mov_b64 exec, 0xffffff
    buffer_load_dwordx4 v[218:221], v246, s[20:23], s0 offen sc1
    s_mov_b64 exec, -1
    s_lshl_b32 s1, s61, 4
    s_add_u32 s0, s64, s1
    v_and_b32 v248, 1, v2
    v_lshlrev_b32 v248, 3, v248
    v_lshl_add_u32 v249, v247, 8, v248
    v_add_u32 v249, s0, v249
    ds_read_b64 v[196:197], v249
    s_lshl_b32 s0, s60, 8
    s_add_u32 s0, s0, s1
    s_add_u32 s0, s0, 157704
    v_mov_b32 v249, s0
    ds_read_b64 v[184:185], v249
    v_lshl_add_u32 v248, v247, 4, v248
    v_mov_b32 v249, 0x3f80
    v_mov_b32 v186, 0x3f800000
    v_cndmask_b32 v249, v249, v186, s[46:47]
    v_lshrrev_b32 v247, 1, v247
    v_cmp_eq_u32 vcc, 0, v247
    s_nop 1
    v_cndmask_b32 v186, 0, v249, vcc
    v_cmp_eq_u32 vcc, 1, v247
    s_nop 1
    v_cndmask_b32 v187, 0, v249, vcc
    v_cmp_eq_u32 vcc, 2, v247
    s_nop 1
    v_cndmask_b32 v188, 0, v249, vcc
    v_cmp_eq_u32 vcc, 3, v247
    s_nop 1
    v_cndmask_b32 v189, 0, v249, vcc
    v_mov_b32 v247, s55
    v_mul_f32 v247, 0xbfb8aa3b, v247
    v_exp_f32 v247, v247
    s_waitcnt lgkmcnt(0)
    v_lshlrev_b32 v194, 16, v196
    v_add_f32 v247, 1.0, v247
    v_rcp_f32 v247, v247
    v_and_b32 v195, 0xffff0000, v196
    v_lshlrev_b32 v196, 16, v197
    v_and_b32 v197, 0xffff0000, v197
    v_fma_f32 v194, v194, v184, v185
    v_fma_f32 v195, v195, v184, v185
    v_fma_f32 v196, v196, v184, v185
    v_fma_f32 v197, v197, v184, v185
    s_mov_b32 s57, 0
    s_branch L_yq_31
L_yp_30:
    s_lshl_b32 s0, s62, 7
    s_add_u32 s0, s0, 6225920
    buffer_load_dwordx4 v[198:201], v246, s[20:23], s0 offen sc1
    s_add_u32 s0, s0, 8192
    buffer_load_dwordx4 v[202:205], v246, s[20:23], s0 offen sc1
    s_add_u32 s0, s0, 8192
    buffer_load_dwordx4 v[206:209], v246, s[20:23], s0 offen sc1
    s_add_u32 s0, s0, 8192
    buffer_load_dwordx4 v[210:213], v246, s[20:23], s0 offen sc1
    s_add_u32 s0, s0, 8192
    buffer_load_dwordx4 v[214:217], v246, s[20:23], s0 offen sc1
    s_add_u32 s0, s0, 8192
    s_mov_b64 exec, 0xffffff
    buffer_load_dwordx4 v[218:221], v246, s[20:23], s0 offen sc1
    s_mov_b64 exec, -1
L_yq_31:
    s_add_u32 s57, s57, 1
    s_cmp_lt_u32 s57, 25000
    s_waitcnt vmcnt(5)
    v_mfma_f32_16x16x32_bf16 v[190:193], v[186:189], v[198:201], 0
    s_waitcnt vmcnt(4)
    v_mfma_f32_16x16x32_bf16 v[190:193], v[186:189], v[202:205], v[190:193]
    s_waitcnt vmcnt(3)
    v_mfma_f32_16x16x32_bf16 v[190:193], v[186:189], v[206:209], v[190:193]
    s_waitcnt vmcnt(2)
    v_mfma_f32_16x16x32_bf16 v[190:193], v[186:189], v[210:213], v[190:193]
    s_waitcnt vmcnt(1)
    v_mfma_f32_16x16x32_bf16 v[190:193], v[186:189], v[214:217], v[190:193]
    s_waitcnt vmcnt(0)
    v_mfma_f32_16x16x32_bf16 v[190:193], v[186:189], v[218:221], v[190:193]
    s_nop 7
    v_cmp_u_f32 vcc, v190, v190
    s_nop 0
    s_cselect_b64 vcc, vcc, 0
    s_cbranch_vccnz L_yp_30
    v_add_f32_dpp v190, v190, v190 row_ror:8 row_mask:0xf bank_mask:0xf
    v_add_f32_dpp v191, v191, v191 row_ror:8 row_mask:0xf bank_mask:0xf
    v_add_f32_dpp v192, v192, v192 row_ror:8 row_mask:0xf bank_mask:0xf
    v_add_f32_dpp v193, v193, v193 row_ror:8 row_mask:0xf bank_mask:0xf
    v_fmac_f32 v194, v190, v247
    v_fmac_f32 v195, v191, v247
    v_fmac_f32 v196, v192, v247
    v_fmac_f32 v197, v193, v247
    v_cvt_pk_bf16_f32 v194, v194, v195
    v_cvt_pk_bf16_f32 v195, v196, v197
    s_mul_i32 s0, s62, 3072
    s_add_u32 s0, s0, s100
    s_cmp_lg_u32 s6, 0
    s_cbranch_scc1 L_slow_32
    s_mov_b64 exec, 0xff00ff
    buffer_store_dwordx2 v[194:195], v248, s[20:23], s0 offen offset:2560
    s_mov_b64 exec, -1
L_back_33:
L_st2_29:
    v_lshrrev_b32 v246, 3, v0
    v_lshlrev_b32 v246, 2, v246
    v_bfe_u32 v246, s96, v246, 3
    v_mul_u32_u24 v246, 3072, v246
    v_and_b32 v247, 7, v0
    v_lshl_add_u32 v246, v247, 4, v246
    v_lshlrev_b32 v247, 8, v0
    v_add_u32 v248, 147456, v247
    v_cmp_gt_u32 vcc, 8, v0
    s_nop 1
    v_cndmask_b32 v247, v247, v248, vcc
    v_lshrrev_b32 v248, 1, v2
    v_lshlrev_b32 v248, 8, v248
    v_and_b32 v249, 1, v2
    v_lshl_add_u32 v248, v249, 3, v248
    s_lshl_b32 s0, s3, 9
    s_add_u32 s0, s0, 147456
    v_add_u32 v248, s0, v248
    v_cmp_eq_u32 s[70:71], s3, v2
    s_mov_b32 s57, 0
    s_barrier
L_rp_34:
    buffer_load_dwordx4 v[198:201], v246, s[20:23], s100 offen offset:2560 sc1
    s_add_u32 s57, s57, 1
    s_cmp_lt_u32 s57, 200000
    s_waitcnt vmcnt(0)
    v_max3_u32 v202, v198, v199, v200
    v_max_u32 v202, v202, v201
    v_cmp_eq_u32 vcc, -1, v202
    s_nop 0
    s_cselect_b64 vcc, vcc, 0
    s_cbranch_vccnz L_rp_34
    s_mov_b64 exec, s[70:71]
    ds_write_b128 v247, v[198:201]
    s_mov_b64 exec, -1
    v_dot2_f32_bf16 v202, v198, v46, 0
    v_dot2_f32_bf16 v203, v198, v198, 0
    v_dot2_f32_bf16 v202, v199, v46, v202
    v_dot2_f32_bf16 v203, v199, v199, v203
    v_dot2_f32_bf16 v202, v200, v46, v202
    v_dot2_f32_bf16 v203, v200, v200, v203
    v_dot2_f32_bf16 v202, v201, v46, v202
    v_dot2_f32_bf16 v203, v201, v201, v203
    s_waitcnt lgkmcnt(0)
    s_barrier
    ds_read_b64 v[208:209], v248
    ds_read_b128 v[134:137], v5 offset:0
    ds_read_b128 v[138:141], v5 offset:1024
    ds_read_b128 v[142:145], v3 offset:2048
    ds_read_b128 v[146:149], v3 offset:3072
    ds_read_b128 v[150:153], v3 offset:4096
    s_waitcnt lgkmcnt(4)
    v_mfma_f32_16x16x32_bf16 v[194:197], v[134:137], a[8:11], 0
    ds_read_b128 v[154:157], v3 offset:5120
    v_add_f32_dpp v202, v202, v202 row_ror:8 row_mask:0xf bank_mask:0xf
    v_mfma_f32_16x16x32_bf16 v[186:189], a[0:3], v[134:137], 0
    v_add_f32_dpp v203, v203, v203 row_ror:8 row_mask:0xf bank_mask:0xf
    v_add_f32_dpp v202, v202, v202 row_ror:4 row_mask:0xf bank_mask:0xf
    v_mfma_f32_16x16x32_bf16 v[190:193], a[4:7], v[134:137], 0
    v_add_f32_dpp v203, v203, v203 row_ror:4 row_mask:0xf bank_mask:0xf
    s_waitcnt lgkmcnt(4)
    v_mfma_f32_16x16x32_bf16 v[194:197], v[138:141], a[20:23], v[194:197]
    ds_read_b128 v[134:137], v3 offset:6144
    v_add_f32_dpp v202, v202, v202 row_ror:2 row_mask:0xf bank_mask:0xf
    v_mfma_f32_16x16x32_bf16 v[186:189], a[12:15], v[138:141], v[186:189]
    v_add_f32_dpp v203, v203, v203 row_ror:2 row_mask:0xf bank_mask:0xf
    v_add_f32_dpp v202, v202, v202 row_ror:1 row_mask:0xf bank_mask:0xf
    v_mfma_f32_16x16x32_bf16 v[190:193], a[16:19], v[138:141], v[190:193]
    v_add_f32_dpp v203, v203, v203 row_ror:1 row_mask:0xf bank_mask:0xf
    s_waitcnt lgkmcnt(4)
    v_mfma_f32_16x16x32_bf16 v[194:197], v[142:145], a[32:35], v[194:197]
    ds_read_b128 v[138:141], v3 offset:7168
    v_mov_b32 v204, v202
    v_mfma_f32_16x16x32_bf16 v[186:189], a[24:27], v[142:145], v[186:189]
    v_mov_b32 v205, v203
    v_mfma_f32_16x16x32_bf16 v[190:193], a[28:31], v[142:145], v[190:193]
    v_permlane32_swap_b32 v202, v204
    s_waitcnt lgkmcnt(4)
    v_mfma_f32_16x16x32_bf16 v[194:197], v[146:149], a[44:47], v[194:197]
    ds_read_b128 v[142:145], v3 offset:8192
    v_mfma_f32_16x16x32_bf16 v[186:189], a[36:39], v[146:149], v[186:189]
    v_permlane32_swap_b32 v203, v205
    v_mfma_f32_16x16x32_bf16 v[190:193], a[40:43], v[146:149], v[190:193]
    v_add_f32 v202, v202, v204
    s_waitcnt lgkmcnt(4)
    v_mfma_f32_16x16x32_bf16 v[194:197], v[150:153], a[56:59], v[194:197]
    ds_read_b128 v[146:149], v3 offset:9216
    v_add_f32 v203, v203, v205
    v_mfma_f32_16x16x32_bf16 v[186:189], a[48:51], v[150:153], v[186:189]
    v_mov_b32 v204, v202
    v_mov_b32 v205, v203
    v_mfma_f32_16x16x32_bf16 v[190:193], a[52:55], v[150:153], v[190:193]
    s_waitcnt lgkmcnt(4)
    v_mfma_f32_16x16x32_bf16 v[194:197], v[154:157], a[68:71], v[194:197]
    ds_read_b128 v[150:153], v3 offset:10240
    v_permlane16_swap_b32 v202, v204
    v_mfma_f32_16x16x32_bf16 v[186:189], a[60:63], v[154:157], v[186:189]
    v_permlane16_swap_b32 v203, v205
    v_mfma_f32_16x16x32_bf16 v[190:193], a[64:67], v[154:157], v[190:193]
    s_waitcnt lgkmcnt(4)
    v_mfma_f32_16x16x32_bf16 v[194:197], v[134:137], a[80:83], v[194:197]
    ds_read_b128 v[154:157], v3 offset:11264
    v_add_f32 v202, v202, v204
    v_mfma_f32_16x16x32_bf16 v[186:189], a[72:75], v[134:137], v[186:189]
    v_add_f32 v203, v203, v205
    v_mul_f32 v204, 0xbb000000, v202
    v_mfma_f32_16x16x32_bf16 v[190:193], a[76:79], v[134:137], v[190:193]
    v_mul_f32 v203, 0x3b000000, v203
    s_waitcnt lgkmcnt(4)
    v_mfma_f32_16x16x32_bf16 v[194:197], v[138:141], a[92:95], v[194:197]
    ds_read_b128 v[134:137], v3 offset:12288
    v_fma_f32 v203, -v204, v204, v203
    v_mfma_f32_16x16x32_bf16 v[186:189], a[84:87], v[138:141], v[186:189]
    v_max_f32 v203, 0, v203
    v_add_f32 v205, 0x3727c5ac, v203
    v_mfma_f32_16x16x32_bf16 v[190:193], a[88:91], v[138:141], v[190:193]
    v_rsq_f32 v205, v205
    s_waitcnt lgkmcnt(4)
    v_mfma_f32_16x16x32_bf16 v[194:197], v[142:145], a[104:107], v[194:197]
    ds_read_b128 v[138:141], v3 offset:13312
    v_mfma_f32_16x16x32_bf16 v[186:189], a[96:99], v[142:145], v[186:189]
    v_lshlrev_b32 v206, 16, v208
    v_and_b32 v207, 0xffff0000, v208
    v_mfma_f32_16x16x32_bf16 v[190:193], a[100:103], v[142:145], v[190:193]
    v_lshlrev_b32 v208, 16, v209
    s_waitcnt lgkmcnt(4)
    v_mfma_f32_16x16x32_bf16 v[194:197], v[146:149], a[116:119], v[194:197]
    ds_read_b128 v[142:145], v3 offset:14336
    v_and_b32 v209, 0xffff0000, v209
    v_mfma_f32_16x16x32_bf16 v[186:189], a[108:111], v[146:149], v[186:189]
    v_cmp_eq_u32 vcc, 0, v1
    v_cmp_eq_u32 s[70:71], 0, v2
    v_mfma_f32_16x16x32_bf16 v[190:193], a[112:115], v[146:149], v[190:193]
    s_waitcnt lgkmcnt(4)
    v_mfma_f32_16x16x32_bf16 v[194:197], v[150:153], a[128:131], v[194:197]
    ds_read_b128 v[146:149], v3 offset:15360
    v_cndmask_b32 v174, v174, v204, vcc
    v_mfma_f32_16x16x32_bf16 v[186:189], a[120:123], v[150:153], v[186:189]
    v_cndmask_b32 v175, v175, v205, vcc
    v_cndmask_b32 v166, v166, v204, s[70:71]
    v_mfma_f32_16x16x32_bf16 v[190:193], a[124:127], v[150:153], v[190:193]
    v_cndmask_b32 v170, v170, v205, s[70:71]
    s_waitcnt lgkmcnt(4)
    v_mfma_f32_16x16x32_bf16 v[194:197], v[154:157], a[140:143], v[194:197]
    v_mul_f32 v205, 0x3eb8aa3b, v205
    v_cmp_eq_u32 s[70:71], s61, v1
    v_mfma_f32_16x16x32_bf16 v[186:189], a[132:135], v[154:157], v[186:189]
    s_lshr_b32 s0, s61, 2
    v_cmp_eq_u32 vcc, s0, v2
    v_mfma_f32_16x16x32_bf16 v[190:193], a[136:139], v[154:157], v[190:193]
    s_mov_b32 s1, 0xffff
    s_waitcnt lgkmcnt(3)
    v_mfma_f32_16x16x32_bf16 v[194:197], v[134:137], a[152:155], v[194:197]
    s_bitcmp1_b32 s61, 0
    s_cselect_b32 s0, 0xffff0000, s1
    v_mfma_f32_16x16x32_bf16 v[186:189], a[144:147], v[134:137], v[186:189]
    s_bitcmp1_b32 s61, 1
    s_cselect_b32 s1, s0, 0
    v_mfma_f32_16x16x32_bf16 v[190:193], a[148:151], v[134:137], v[190:193]
    s_cselect_b32 s0, 0, s0
    s_waitcnt lgkmcnt(2)
    v_mfma_f32_16x16x32_bf16 v[194:197], v[138:141], a[164:167], v[194:197]
    v_mfma_f32_16x16x32_bf16 v[186:189], a[156:159], v[138:141], v[186:189]
    v_mfma_f32_16x16x32_bf16 v[190:193], a[160:163], v[138:141], v[190:193]
    s_waitcnt lgkmcnt(1)
    v_mfma_f32_16x16x32_bf16 v[194:197], v[142:145], a[176:179], v[194:197]
    v_mfma_f32_16x16x32_bf16 v[186:189], a[168:171], v[142:145], v[186:189]
    v_mfma_f32_16x16x32_bf16 v[190:193], a[172:175], v[142:145], v[190:193]
    s_waitcnt lgkmcnt(0)
    v_mfma_f32_16x16x32_bf16 v[194:197], v[146:149], a[188:191], v[194:197]
    v_mfma_f32_16x16x32_bf16 v[186:189], a[180:183], v[146:149], v[186:189]
    v_mfma_f32_16x16x32_bf16 v[190:193], a[184:187], v[146:149], v[190:193]
    s_nop 6
    v_pk_fma_f32 v[186:187], v[28:29], v[174:175], v[186:187] op_sel_hi:[1,0,1]
    v_pk_fma_f32 v[190:191], v[32:33], v[174:175], v[190:191] op_sel_hi:[1,0,1]
    v_pk_fma_f32 v[194:195], v[36:37], v[166:167], v[194:195] op_sel_hi:[0,1,1]
    v_pk_fma_f32 v[188:189], v[30:31], v[174:175], v[188:189] op_sel_hi:[1,0,1]
    v_pk_fma_f32 v[192:193], v[34:35], v[174:175], v[192:193] op_sel_hi:[1,0,1]
    v_pk_fma_f32 v[196:197], v[36:37], v[168:169], v[196:197] op_sel_hi:[0,1,1]
    v_pk_mul_f32 v[190:191], v[190:191], v[174:175] op_sel:[0,1] op_sel_hi:[1,1]
    v_pk_mul_f32 v[194:195], v[194:195], v[170:171]
    v_pk_mul_f32 v[192:193], v[192:193], v[174:175] op_sel:[0,1] op_sel_hi:[1,1]
    v_pk_mul_f32 v[196:197], v[196:197], v[172:173]
    v_cvt_pk_bf16_f32 v214, v194, v194
    v_cvt_pk_bf16_f32 v215, v194, v194
    v_cvt_pk_bf16_f32 v102, v186, v187
    v_cvt_pk_bf16_f32 v103, v188, v189
    v_permlane16_swap_b32 v214, v215
    v_cvt_pk_bf16_f32 v112, v190, v191
    v_cvt_pk_bf16_f32 v113, v192, v193
    v_mov_b32 v215, v214
    v_cvt_pk_bf16_f32 v124, v194, v195
    v_cvt_pk_bf16_f32 v125, v196, v197
    v_permlane32_swap_b32 v214, v215
    v_mov_b32_dpp v210, v102 row_newbcast:0 row_mask:0xf bank_mask:0xf
    v_mov_b32_dpp v212, v112 row_newbcast:0 row_mask:0xf bank_mask:0xf
    v_mov_b32_dpp v211, v103 row_newbcast:0 row_mask:0xf bank_mask:0xf
    v_mov_b32_dpp v213, v113 row_newbcast:0 row_mask:0xf bank_mask:0xf
    s_cmp_eq_u32 s60, 0
    s_cbranch_scc0 L_pt_35
    s_mov_b64 exec, s[70:71]
    v_mov_b32 v112, v212
    v_mov_b32 v113, v213
    s_mov_b64 exec, vcc
    v_bfi_b32 v124, s0, v214, v124
    v_bfi_b32 v125, s1, v214, v125
    s_mov_b64 exec, -1
L_pt_35:
    s_cmp_eq_u32 s60, 1
    s_cbranch_scc0 L_pt_36
    s_mov_b64 exec, s[70:71]
    v_mov_b32 v104, v210
    v_mov_b32 v114, v212
    v_mov_b32 v105, v211
    v_mov_b32 v115, v213
    v_mov_b32 v177, v205
    v_mov_b32 v54, v206
    v_mov_b32 v55, v207
    v_mov_b32 v56, v208
    v_mov_b32 v57, v209
    s_mov_b64 exec, vcc
    v_bfi_b32 v126, s0, v214, v126
    v_bfi_b32 v127, s1, v214, v127
    s_mov_b64 exec, -1
L_pt_36:
    s_cmp_eq_u32 s60, 2
    s_cbranch_scc0 L_pt_37
    s_mov_b64 exec, s[70:71]
    v_mov_b32 v106, v210
    v_mov_b32 v116, v212
    v_mov_b32 v107, v211
    v_mov_b32 v117, v213
    v_mov_b32 v179, v205
    v_mov_b32 v58, v206
    v_mov_b32 v59, v207
    v_mov_b32 v60, v208
    v_mov_b32 v61, v209
    s_mov_b64 exec, vcc
    v_bfi_b32 v128, s0, v214, v128
    v_bfi_b32 v129, s1, v214, v129
    s_mov_b64 exec, -1
L_pt_37:
    s_cmp_eq_u32 s60, 3
    s_cbranch_scc0 L_pt_38
    s_mov_b64 exec, s[70:71]
    v_mov_b32 v108, v210
    v_mov_b32 v118, v212
    v_mov_b32 v109, v211
    v_mov_b32 v119, v213
    v_mov_b32 v181, v205
    v_mov_b32 v62, v206
    v_mov_b32 v63, v207
    v_mov_b32 v64, v208
    v_mov_b32 v65, v209
    s_mov_b64 exec, vcc
    v_bfi_b32 v130, s0, v214, v130
    v_bfi_b32 v131, s1, v214, v131
    s_mov_b64 exec, -1
L_pt_38:
    s_cmp_eq_u32 s60, 4
    s_cbranch_scc0 L_pt_39
    s_mov_b64 exec, s[70:71]
    v_mov_b32 v110, v210
    v_mov_b32 v120, v212
    v_mov_b32 v111, v211
    v_mov_b32 v121, v213
    v_mov_b32 v183, v205
    v_mov_b32 v66, v206
    v_mov_b32 v67, v207
    v_mov_b32 v68, v208
    v_mov_b32 v69, v209
    s_mov_b64 exec, vcc
    v_bfi_b32 v132, s0, v214, v132
    v_bfi_b32 v133, s1, v214, v133
    s_mov_b64 exec, -1
L_pt_39:
L_attn1:
    v_mfma_f32_16x16x16_bf16 v[198:201], v[114:115], v[104:105], v[20:23]
    v_mfma_f32_16x16x16_bf16 v[202:205], v[112:113], v[104:105], v[250:253]
    v_mfma_f32_16x16x16_bf16 v[210:213], v[116:117], v[106:107], v[20:23]
    v_mfma_f32_16x16x16_bf16 v[214:217], v[114:115], v[106:107], v[24:27]
    v_mfma_f32_16x16x16_bf16 v[222:225], v[118:119], v[108:109], v[20:23]
    v_mfma_f32_16x16x16_bf16 v[226:229], v[116:117], v[108:109], v[24:27]
    v_mfma_f32_16x16x16_bf16 v[234:237], v[120:121], v[110:111], v[20:23]
    v_mfma_f32_16x16x16_bf16 v[238:241], v[118:119], v[110:111], v[24:27]
    s_nop 1
    v_max_f32 v198, v198, v202
    v_max_f32 v199, v199, v203
    v_max_f32 v200, v200, v204
    v_max_f32 v201, v201, v205
    v_max3_f32 v135, v198, v199, v200
    v_max_f32 v135, v135, v201
    v_mov_b32 v141, v135
    v_max_f32 v210, v210, v214
    v_max_f32 v211, v211, v215
    v_max_f32 v212, v212, v216
    v_max_f32 v213, v213, v217
    v_max3_f32 v136, v210, v211, v212
    v_max_f32 v136, v136, v213
    v_mov_b32 v142, v136
    v_max_f32 v222, v222, v226
    v_max_f32 v223, v223, v227
    v_max_f32 v224, v224, v228
    v_max_f32 v225, v225, v229
    v_max3_f32 v137, v222, v223, v224
    v_max_f32 v137, v137, v225
    v_mov_b32 v143, v137
    v_max_f32 v234, v234, v238
    v_max_f32 v235, v235, v239
    v_max_f32 v236, v236, v240
    v_max_f32 v237, v237, v241
    v_max3_f32 v138, v234, v235, v236
    v_max_f32 v138, v138, v237
    v_mov_b32 v144, v138
    v_permlane32_swap_b32 v135, v141
    v_permlane32_swap_b32 v136, v142
    v_permlane32_swap_b32 v137, v143
    v_permlane32_swap_b32 v138, v144
    v_max_f32 v135, v135, v141
    v_mov_b32 v141, v135
    v_max_f32 v136, v136, v142
    v_mov_b32 v142, v136
    v_max_f32 v137, v137, v143
    v_mov_b32 v143, v137
    v_max_f32 v138, v138, v144
    v_mov_b32 v144, v138
    v_permlane16_swap_b32 v135, v141
    v_permlane16_swap_b32 v136, v142
    v_permlane16_swap_b32 v137, v143
    v_permlane16_swap_b32 v138, v144
    v_max_f32 v135, v135, v141
    v_mul_f32 v135, v135, v177
    v_pk_fma_f32 v[198:199], v[198:199], v[176:177], v[134:135] op_sel:[0,1,1] op_sel_hi:[1,1,1] neg_lo:[0,0,1] neg_hi:[0,0,1]
    v_pk_fma_f32 v[200:201], v[200:201], v[176:177], v[134:135] op_sel:[0,1,1] op_sel_hi:[1,1,1] neg_lo:[0,0,1] neg_hi:[0,0,1]
    v_max_f32 v136, v136, v142
    v_mul_f32 v136, v136, v179
    v_pk_fma_f32 v[210:211], v[210:211], v[178:179], v[136:137] op_sel:[0,1,0] op_sel_hi:[1,1,0] neg_lo:[0,0,1] neg_hi:[0,0,1]
    v_pk_fma_f32 v[212:213], v[212:213], v[178:179], v[136:137] op_sel:[0,1,0] op_sel_hi:[1,1,0] neg_lo:[0,0,1] neg_hi:[0,0,1]
    v_max_f32 v137, v137, v143
    v_mul_f32 v137, v137, v181
    v_pk_fma_f32 v[222:223], v[222:223], v[180:181], v[136:137] op_sel:[0,1,1] op_sel_hi:[1,1,1] neg_lo:[0,0,1] neg_hi:[0,0,1]
    v_pk_fma_f32 v[224:225], v[224:225], v[180:181], v[136:137] op_sel:[0,1,1] op_sel_hi:[1,1,1] neg_lo:[0,0,1] neg_hi:[0,0,1]
    v_max_f32 v138, v138, v144
    v_mul_f32 v138, v138, v183
    v_pk_fma_f32 v[234:235], v[234:235], v[182:183], v[138:139] op_sel:[0,1,0] op_sel_hi:[1,1,0] neg_lo:[0,0,1] neg_hi:[0,0,1]
    v_pk_fma_f32 v[236:237], v[236:237], v[182:183], v[138:139] op_sel:[0,1,0] op_sel_hi:[1,1,0] neg_lo:[0,0,1] neg_hi:[0,0,1]
    v_exp_f32 v198, v198
    v_exp_f32 v199, v199
    v_exp_f32 v200, v200
    v_exp_f32 v201, v201
    v_cvt_pk_bf16_f32 v168, v198, v199
    v_cvt_pk_bf16_f32 v169, v200, v201
    v_bfi_b32 v150, v18, 0, v168
    v_and_b32 v152, v18, v168
    v_bfi_b32 v151, v19, 0, v169
    v_and_b32 v153, v19, v169
    v_mfma_f32_16x16x16_bf16 v[202:205], v[46:47], v[168:169], 0
    v_exp_f32 v210, v210
    v_mfma_f32_16x16x32_bf16 v[198:201], v[124:127], v[150:153], 0
    v_exp_f32 v211, v211
    v_exp_f32 v212, v212
    v_exp_f32 v213, v213
    v_cvt_pk_bf16_f32 v170, v210, v211
    v_cvt_pk_bf16_f32 v171, v212, v213
    v_bfi_b32 v154, v18, 0, v170
    v_and_b32 v156, v18, v170
    v_bfi_b32 v155, v19, 0, v171
    v_and_b32 v157, v19, v171
    v_mfma_f32_16x16x16_bf16 v[214:217], v[46:47], v[170:171], 0
    v_exp_f32 v222, v222
    v_mfma_f32_16x16x32_bf16 v[210:213], v[126:129], v[154:157], 0
    v_exp_f32 v223, v223
    v_exp_f32 v224, v224
    v_exp_f32 v225, v225
    v_cvt_pk_bf16_f32 v172, v222, v223
    v_cvt_pk_bf16_f32 v173, v224, v225
    v_bfi_b32 v158, v18, 0, v172
    v_and_b32 v160, v18, v172
    v_bfi_b32 v159, v19, 0, v173
    v_and_b32 v161, v19, v173
    v_mfma_f32_16x16x16_bf16 v[226:229], v[46:47], v[172:173], 0
    v_exp_f32 v234, v234
    v_mfma_f32_16x16x32_bf16 v[222:225], v[128:131], v[158:161], 0
    v_exp_f32 v235, v235
    v_exp_f32 v236, v236
    v_exp_f32 v237, v237
    v_cvt_pk_bf16_f32 v184, v234, v235
    v_cvt_pk_bf16_f32 v185, v236, v237
    v_bfi_b32 v162, v18, 0, v184
    v_and_b32 v164, v18, v184
    v_bfi_b32 v163, v19, 0, v185
    v_and_b32 v165, v19, v185
    v_mfma_f32_16x16x16_bf16 v[238:241], v[46:47], v[184:185], 0
    s_nop 0
    v_mfma_f32_16x16x32_bf16 v[234:237], v[130:133], v[162:165], 0
    v_rcp_f32 v202, v202
    v_rcp_f32 v214, v214
    v_rcp_f32 v226, v226
    s_nop 2
    v_rcp_f32 v238, v238
    v_pk_mul_f32 v[198:199], v[198:199], v[202:203] op_sel_hi:[1,0]
    v_pk_mul_f32 v[200:201], v[200:201], v[202:203] op_sel_hi:[1,0]
    v_cvt_pk_bf16_f32 v102, v198, v199
    v_cvt_pk_bf16_f32 v103, v200, v201
    v_pk_mul_f32 v[210:211], v[210:211], v[214:215] op_sel_hi:[1,0]
    v_pk_mul_f32 v[212:213], v[212:213], v[214:215] op_sel_hi:[1,0]
    v_cvt_pk_bf16_f32 v104, v210, v211
    v_cvt_pk_bf16_f32 v105, v212, v213
    v_pk_mul_f32 v[222:223], v[222:223], v[226:227] op_sel_hi:[1,0]
    v_pk_mul_f32 v[224:225], v[224:225], v[226:227] op_sel_hi:[1,0]
    v_cvt_pk_bf16_f32 v106, v222, v223
    v_cvt_pk_bf16_f32 v107, v224, v225
    v_pk_mul_f32 v[234:235], v[234:235], v[238:239] op_sel_hi:[1,0]
    v_pk_mul_f32 v[236:237], v[236:237], v[238:239] op_sel_hi:[1,0]
    v_cvt_pk_bf16_f32 v108, v234, v235
    v_cvt_pk_bf16_f32 v109, v236, v237
    v_permlane16_swap_b32 v102, v104
    v_permlane16_swap_b32 v103, v105
    v_permlane16_swap_b32 v106, v108
    v_permlane16_swap_b32 v107, v109
    s_cmp_lg_u32 s6, 0
    s_cbranch_scc1 L_slow_40
    s_mov_b32 s0, 81920
    buffer_store_dwordx4 v[102:105], v10, s[20:23], s0 offen
    s_mov_b32 s0, 114688
    buffer_store_dwordx4 v[106:109], v10, s[20:23], s0 offen
L_back_41:
    s_barrier
    ds_write_b128 v11, v[102:105] offset:2048
    ds_write_b128 v11, v[106:109] offset:6144
    s_lshl_b32 s0, s4, 2
    s_add_u32 s0, s0, s3
    s_lshl_b64 s[70:71], 1, s0
    v_mov_b32 v246, s53
    s_waitcnt vmcnt(0) lgkmcnt(0)
    s_cmp_lg_u32 s6, 0
    s_cbranch_scc1 L_slow_42
    s_mov_b64 exec, s[70:71]
    buffer_store_dword v246, v15, s[20:23], 0 offen offset:768
    s_mov_b64 exec, -1
L_back_43:
    s_barrier
    ds_read_b128 v[134:137], v5 offset:2048
    ds_read_b128 v[138:141], v5 offset:3072
    ds_read_b128 v[142:145], v5 offset:4096
    ds_read_b128 v[146:149], v5 offset:5120
    ds_read_b128 v[150:153], v5 offset:6144
    ds_read_b128 v[154:157], v5 offset:7168
    ds_read_b128 v[158:161], v5 offset:8192
    ds_read_b128 v[162:165], v5 offset:9216
    s_waitcnt lgkmcnt(6)
    v_mfma_f32_16x16x32_bf16 v[54:57], a[192:195], v[134:137], v[54:57]
    v_mfma_f32_16x16x32_bf16 v[54:57], a[196:199], v[138:141], v[54:57]
    s_waitcnt lgkmcnt(4)
    v_mfma_f32_16x16x32_bf16 v[58:61], a[192:195], v[142:145], v[58:61]
    v_mfma_f32_16x16x32_bf16 v[58:61], a[196:199], v[146:149], v[58:61]
    s_waitcnt lgkmcnt(2)
    v_mfma_f32_16x16x32_bf16 v[62:65], a[192:195], v[150:153], v[62:65]
    v_mfma_f32_16x16x32_bf16 v[62:65], a[196:199], v[154:157], v[62:65]
    s_waitcnt lgkmcnt(0)
    v_mfma_f32_16x16x32_bf16 v[66:69], a[192:195], v[158:161], v[66:69]
    v_mfma_f32_16x16x32_bf16 v[66:69], a[196:199], v[162:165], v[66:69]
    s_mov_b32 s57, 0
L_poll_44:
    buffer_load_dword v247, v15, s[20:23], 0 offen offset:768 sc1
    s_waitcnt vmcnt(0)
    v_cmp_eq_u32 vcc, -1, v247
    s_add_u32 s57, s57, 1
    s_cmp_gt_u32 s57, 200000
    s_cbranch_scc1 L_end
    s_cbranch_vccnz L_poll_44
    s_add_u32 m0, s58, 18432
    s_mov_b32 s59, 77824
    buffer_load_dwordx4 v6, s[20:23], s59 offen offset:0 sc1 lds
    buffer_load_dwordx4 v7, s[20:23], s59 offen offset:1024 sc1 lds
    buffer_load_dwordx4 v8, s[20:23], s59 offen offset:2048 sc1 lds
    s_mov_b32 exec_hi, 0
    buffer_load_dwordx4 v9, s[20:23], s59 offen offset:3072 sc1 lds
    s_mov_b32 exec_hi, -1
    s_add_u32 m0, s58, 34816
    s_mov_b32 s59, 94208
    buffer_load_dwordx4 v6, s[20:23], s59 offen offset:0 sc1 lds
    buffer_load_dwordx4 v7, s[20:23], s59 offen offset:1024 sc1 lds
    buffer_load_dwordx4 v8, s[20:23], s59 offen offset:2048 sc1 lds
    s_mov_b32 exec_hi, 0
    buffer_load_dwordx4 v9, s[20:23], s59 offen offset:3072 sc1 lds
    s_mov_b32 exec_hi, -1
    s_waitcnt vmcnt(4)
    s_barrier
    ds_read_b128 v[134:137], v3 offset:18432
    ds_read_b128 v[138:141], v3 offset:19456
    s_add_u32 m0, s58, 51200
    s_mov_b32 s59, 110592
    buffer_load_dwordx4 v6, s[20:23], s59 offen offset:0 sc1 lds
    ds_read_b128 v[142:145], v3 offset:20480
    ds_read_b128 v[146:149], v3 offset:21504
    ds_read_b128 v[150:153], v3 offset:22528
    buffer_load_dwordx4 v7, s[20:23], s59 offen offset:1024 sc1 lds
    ds_read_b128 v[154:157], v3 offset:23552
    ds_read_b128 v[158:161], v3 offset:24576
    ds_read_b128 v[162:165], v3 offset:25600
    buffer_load_dwordx4 v8, s[20:23], s59 offen offset:2048 sc1 lds
    ds_read_b128 v[166:169], v3 offset:26624
    s_waitcnt lgkmcnt(7)
    v_mfma_f32_16x16x32_bf16 v[54:57], a[200:203], v[134:137], v[54:57]
    ds_read_b128 v[170:173], v3 offset:27648
    v_mfma_f32_16x16x32_bf16 v[54:57], a[204:207], v[138:141], v[54:57]
    ds_read_b128 v[174:177], v3 offset:28672
    s_waitcnt lgkmcnt(7)
    v_mfma_f32_16x16x32_bf16 v[54:57], a[208:211], v[142:145], v[54:57]
    s_mov_b32 exec_hi, 0
    buffer_load_dwordx4 v9, s[20:23], s59 offen offset:3072 sc1 lds
    s_mov_b32 exec_hi, -1
    ds_read_b128 v[178:181], v3 offset:29696
    v_mfma_f32_16x16x32_bf16 v[54:57], a[212:215], v[146:149], v[54:57]
    ds_read_b128 v[134:137], v3 offset:30720
    s_waitcnt lgkmcnt(7)
    v_mfma_f32_16x16x32_bf16 v[54:57], a[216:219], v[150:153], v[54:57]
    ds_read_b128 v[138:141], v3 offset:31744
    v_mfma_f32_16x16x32_bf16 v[54:57], a[220:223], v[154:157], v[54:57]
    s_add_u32 m0, s58, 67584
    s_mov_b32 s59, 126976
    buffer_load_dwordx4 v6, s[20:23], s59 offen offset:0 sc1 lds
    s_waitcnt vmcnt(5)
    s_barrier
    ds_read_b128 v[142:145], v3 offset:34816
    s_waitcnt lgkmcnt(7)
    v_mfma_f32_16x16x32_bf16 v[54:57], a[224:227], v[158:161], v[54:57]
    ds_read_b128 v[146:149], v3 offset:35840
    v_mfma_f32_16x16x32_bf16 v[54:57], a[228:231], v[162:165], v[54:57]
    ds_read_b128 v[150:153], v3 offset:36864
    s_waitcnt lgkmcnt(7)
    v_mfma_f32_16x16x32_bf16 v[54:57], a[232:235], v[166:169], v[54:57]
    buffer_load_dwordx4 v7, s[20:23], s59 offen offset:1024 sc1 lds
    ds_read_b128 v[154:157], v3 offset:37888
    v_mfma_f32_16x16x32_bf16 v[54:57], a[236:239], v[170:173], v[54:57]
    ds_read_b128 v[158:161], v3 offset:38912
    s_waitcnt lgkmcnt(7)
    v_mfma_f32_16x16x32_bf16 v[54:57], a[240:243], v[174:177], v[54:57]
    ds_read_b128 v[162:165], v3 offset:39936
    v_mfma_f32_16x16x32_bf16 v[54:57], a[244:247], v[178:181], v[54:57]
    buffer_load_dwordx4 v8, s[20:23], s59 offen offset:2048 sc1 lds
    ds_read_b128 v[166:169], v3 offset:40960
    s_waitcnt lgkmcnt(7)
    v_mfma_f32_16x16x32_bf16 v[54:57], a[248:251], v[134:137], v[54:57]
    ds_read_b128 v[170:173], v3 offset:41984
    v_mfma_f32_16x16x32_bf16 v[54:57], a[252:255], v[138:141], v[54:57]
    ds_read_b128 v[174:177], v3 offset:43008
    s_waitcnt lgkmcnt(7)
    v_mfma_f32_16x16x32_bf16 v[58:61], a[200:203], v[142:145], v[58:61]
    s_mov_b32 exec_hi, 0
    buffer_load_dwordx4 v9, s[20:23], s59 offen offset:3072 sc1 lds
    s_mov_b32 exec_hi, -1
    ds_read_b128 v[178:181], v3 offset:44032
    v_mfma_f32_16x16x32_bf16 v[58:61], a[204:207], v[146:149], v[58:61]
    ds_read_b128 v[134:137], v3 offset:45056
    s_waitcnt lgkmcnt(7)
    v_mfma_f32_16x16x32_bf16 v[58:61], a[208:211], v[150:153], v[58:61]
    ds_read_b128 v[138:141], v3 offset:46080
    v_mfma_f32_16x16x32_bf16 v[58:61], a[212:215], v[154:157], v[58:61]
    ds_read_b128 v[142:145], v3 offset:47104
    s_waitcnt lgkmcnt(7)
    v_mfma_f32_16x16x32_bf16 v[58:61], a[216:219], v[158:161], v[58:61]
    ds_read_b128 v[146:149], v3 offset:48128
    v_mfma_f32_16x16x32_bf16 v[58:61], a[220:223], v[162:165], v[58:61]
    s_waitcnt vmcnt(4)
    s_barrier
    ds_read_b128 v[150:153], v3 offset:51200
    s_waitcnt lgkmcnt(7)
    v_mfma_f32_16x16x32_bf16 v[58:61], a[224:227], v[166:169], v[58:61]
    ds_read_b128 v[154:157], v3 offset:52224
    v_mfma_f32_16x16x32_bf16 v[58:61], a[228:231], v[170:173], v[58:61]
    ds_read_b128 v[158:161], v3 offset:53248
    s_waitcnt lgkmcnt(7)
    v_mfma_f32_16x16x32_bf16 v[58:61], a[232:235], v[174:177], v[58:61]
    ds_read_b128 v[162:165], v3 offset:54272
    v_mfma_f32_16x16x32_bf16 v[58:61], a[236:239], v[178:181], v[58:61]
    ds_read_b128 v[166:169], v3 offset:55296
    s_waitcnt lgkmcnt(7)
    v_mfma_f32_16x16x32_bf16 v[58:61], a[240:243], v[134:137], v[58:61]
    ds_read_b128 v[170:173], v3 offset:56320
    v_mfma_f32_16x16x32_bf16 v[58:61], a[244:247], v[138:141], v[58:61]
    ds_read_b128 v[174:177], v3 offset:57344
    s_waitcnt lgkmcnt(7)
    v_mfma_f32_16x16x32_bf16 v[58:61], a[248:251], v[142:145], v[58:61]
    ds_read_b128 v[178:181], v3 offset:58368
    v_mfma_f32_16x16x32_bf16 v[58:61], a[252:255], v[146:149], v[58:61]
    ds_read_b128 v[134:137], v3 offset:59392
    s_waitcnt lgkmcnt(7)
    v_mfma_f32_16x16x32_bf16 v[62:65], a[200:203], v[150:153], v[62:65]
    ds_read_b128 v[138:141], v3 offset:60416
    v_mfma_f32_16x16x32_bf16 v[62:65], a[204:207], v[154:157], v[62:65]
    ds_read_b128 v[142:145], v3 offset:61440
    s_waitcnt lgkmcnt(7)
    v_mfma_f32_16x16x32_bf16 v[62:65], a[208:211], v[158:161], v[62:65]
    ds_read_b128 v[146:149], v3 offset:62464
    v_mfma_f32_16x16x32_bf16 v[62:65], a[212:215], v[162:165], v[62:65]
    ds_read_b128 v[150:153], v3 offset:63488
    s_waitcnt lgkmcnt(7)
    v_mfma_f32_16x16x32_bf16 v[62:65], a[216:219], v[166:169], v[62:65]
    ds_read_b128 v[154:157], v3 offset:64512
    v_mfma_f32_16x16x32_bf16 v[62:65], a[220:223], v[170:173], v[62:65]
    s_waitcnt vmcnt(0)
    s_barrier
    ds_read_b128 v[158:161], v4 offset:2048
    s_waitcnt lgkmcnt(7)
    v_mfma_f32_16x16x32_bf16 v[62:65], a[224:227], v[174:177], v[62:65]
    ds_read_b128 v[162:165], v4 offset:3072
    v_mfma_f32_16x16x32_bf16 v[62:65], a[228:231], v[178:181], v[62:65]
    ds_read_b128 v[166:169], v4 offset:4096
    s_waitcnt lgkmcnt(7)
    v_mfma_f32_16x16x32_bf16 v[62:65], a[232:235], v[134:137], v[62:65]
    ds_read_b128 v[170:173], v4 offset:5120
    v_mfma_f32_16x16x32_bf16 v[62:65], a[236:239], v[138:141], v[62:65]
    ds_read_b128 v[174:177], v4 offset:6144
    s_waitcnt lgkmcnt(7)
    v_mfma_f32_16x16x32_bf16 v[62:65], a[240:243], v[142:145], v[62:65]
    ds_read_b128 v[178:181], v4 offset:7168
    v_mfma_f32_16x16x32_bf16 v[62:65], a[244:247], v[146:149], v[62:65]
    ds_read_b128 v[134:137], v4 offset:8192
    s_waitcnt lgkmcnt(7)
    v_mfma_f32_16x16x32_bf16 v[62:65], a[248:251], v[150:153], v[62:65]
    ds_read_b128 v[138:141], v4 offset:9216
    v_mfma_f32_16x16x32_bf16 v[62:65], a[252:255], v[154:157], v[62:65]
    ds_read_b128 v[142:145], v4 offset:10240
    s_waitcnt lgkmcnt(7)
    v_mfma_f32_16x16x32_bf16 v[66:69], a[200:203], v[158:161], v[66:69]
    ds_read_b128 v[146:149], v4 offset:11264
    v_mfma_f32_16x16x32_bf16 v[66:69], a[204:207], v[162:165], v[66:69]
    ds_read_b128 v[150:153], v4 offset:12288
    s_waitcnt lgkmcnt(7)
    v_mfma_f32_16x16x32_bf16 v[66:69], a[208:211], v[166:169], v[66:69]
    ds_read_b128 v[154:157], v4 offset:13312
    v_mfma_f32_16x16x32_bf16 v[66:69], a[212:215], v[170:173], v[66:69]
    ds_read_b128 v[158:161], v4 offset:14336
    s_waitcnt lgkmcnt(7)
    v_mfma_f32_16x16x32_bf16 v[66:69], a[216:219], v[174:177], v[66:69]
    ds_read_b128 v[162:165], v4 offset:15360
    v_mfma_f32_16x16x32_bf16 v[66:69], a[220:223], v[178:181], v[66:69]
    s_waitcnt lgkmcnt(6)
    v_mfma_f32_16x16x32_bf16 v[66:69], a[224:227], v[134:137], v[66:69]
    v_mfma_f32_16x16x32_bf16 v[66:69], a[228:231], v[138:141], v[66:69]
    s_waitcnt lgkmcnt(4)
    v_mfma_f32_16x16x32_bf16 v[66:69], a[232:235], v[142:145], v[66:69]
    v_mfma_f32_16x16x32_bf16 v[66:69], a[236:239], v[146:149], v[66:69]
    s_waitcnt lgkmcnt(2)
    v_mfma_f32_16x16x32_bf16 v[66:69], a[240:243], v[150:153], v[66:69]
    v_mfma_f32_16x16x32_bf16 v[66:69], a[244:247], v[154:157], v[66:69]
    s_waitcnt lgkmcnt(0)
    v_mfma_f32_16x16x32_bf16 v[66:69], a[248:251], v[158:161], v[66:69]
    v_mfma_f32_16x16x32_bf16 v[66:69], a[252:255], v[162:165], v[66:69]
    v_cvt_pk_bf16_f32 v102, v54, v55
    v_cvt_pk_bf16_f32 v103, v56, v57
    v_cvt_pk_bf16_f32 v104, v58, v59
    v_cvt_pk_bf16_f32 v105, v60, v61
    v_cvt_pk_bf16_f32 v106, v62, v63
    v_cvt_pk_bf16_f32 v107, v64, v65
    s_nop 1
    v_cvt_pk_bf16_f32 v108, v66, v67
    v_cvt_pk_bf16_f32 v109, v68, v69
    v_permlane16_swap_b32 v102, v104
    v_permlane16_swap_b32 v103, v105
    v_permlane16_swap_b32 v106, v108
    v_permlane16_swap_b32 v107, v109
    ds_write_b128 v11, v[102:105] offset:2048
    ds_write_b128 v11, v[106:109] offset:6144
    s_lshl_b32 s0, s3, 11
    v_add_u32 v246, s0, v5
    s_cmp_eq_u32 s3, 0
    s_cselect_b32 s0, 63, 15
    s_cselect_b32 s1, 256, 0
    v_and_b32 v247, s0, v0
    v_lshl_add_u32 v247, v247, 4, s1
    s_waitcnt lgkmcnt(0)
    s_barrier
    ds_read_b128 v[134:137], v246 offset:2048
    ds_read_b128 v[138:141], v246 offset:3072
    s_waitcnt lgkmcnt(0)
    v_mfma_f32_16x16x32_bf16 v[146:149], v[134:137], v[134:137], 0
    v_mfma_f32_16x16x32_bf16 v[146:149], v[138:141], v[138:141], v[146:149]
    v_mfma_f32_16x16x32_bf16 v[142:145], v[38:41], v[134:137], 0
    v_mfma_f32_16x16x32_bf16 v[142:145], v[42:45], v[138:141], v[142:145]
    s_nop 5
    v_cndmask_b32 v146, v146, v147, s[46:47]
    v_cndmask_b32 v148, v148, v149, s[46:47]
    v_cndmask_b32 v144, v146, v148, s[48:49]
    v_mov_b32 v145, 0
    s_cmp_lg_u32 s6, 0
    s_cbranch_scc1 L_slow_45
    s_mov_b64 exec, s[44:45]
    buffer_store_dwordx4 v[142:145], v14, s[20:23], 0 offen offset:1280
    s_mov_b64 exec, -1
L_back_46:
    v_and_b32 v254, 31, v0
    v_lshlrev_b32 v254, 11, v254
    v_lshrrev_b32 v255, 5, v0
    v_lshl_add_u32 v254, v255, 4, v254
    s_and_b32 s0, s5, 15
    s_lshl_b32 s0, s0, 17
    s_lshr_b32 s1, s5, 4
    s_lshl_b32 s1, s1, 10
    s_add_u32 s0, s0, s1
    s_lshl_b32 s1, s4, 7
    s_add_u32 s64, s0, s1
    s_lshl_b32 s1, s3, 5
    s_add_u32 s65, s64, s1
    s_add_u32 s69, s65, 65536
    v_lshrrev_b32 v124, 2, v1
    v_lshl_add_u32 v124, v2, 3, v124
    v_lshlrev_b32 v124, 6, v124
    v_and_b32 v131, 3, v0
    v_lshl_add_u32 v124, v131, 3, v124
    v_and_b32 v131, 1, v2
    v_lshl_add_u32 v124, v131, 5, v124
    v_add_u32 v124, s63, v124
    v_add_u32 v124, 81920, v124
    v_xor_b32 v125, 32, v124
    v_lshlrev_b32 v129, 4, v2
    v_lshl_add_u32 v126, s3, 8, v129
    v_add_u32 v126, 160768, v126
    v_lshrrev_b32 v127, 3, v1
    v_lshl_add_u32 v127, v127, 2, v2
    v_and_b32 v131, 7, v1
    v_lshl_add_u32 v127, v127, 3, v131
    v_lshlrev_b32 v127, 2, v127
    v_add_u32 v127, 160768, v127
    v_lshlrev_b32 v128, 4, v1
    v_lshl_add_u32 v128, s3, 8, v128
    v_lshl_add_u32 v128, v2, 3, v128
    v_lshlrev_b32 v131, 4, v131
    v_subrev_u32 v118, 0, v131
    v_cmp_gt_u32 vcc, 32, v118
    v_bfm_b32 v118, 16, v118
    s_nop 0
    v_cndmask_b32 v118, 0, v118, vcc
    v_subrev_u32 v119, 32, v131
    v_cmp_gt_u32 vcc, 32, v119
    v_bfm_b32 v119, 16, v119
    s_nop 0
    v_cndmask_b32 v119, 0, v119, vcc
    v_subrev_u32 v120, 64, v131
    v_cmp_gt_u32 vcc, 32, v120
    v_bfm_b32 v120, 16, v120
    s_nop 0
    v_cndmask_b32 v120, 0, v120, vcc
    v_subrev_u32 v121, 96, v131
    v_cmp_gt_u32 vcc, 32, v121
    v_bfm_b32 v121, 16, v121
    s_nop 0
    v_cndmask_b32 v121, 0, v121, vcc
    s_lshl_b32 s66, s7, 10
    s_add_u32 s66, s66, 6275072
    s_cmp_gt_u32 s3, 0
    s_cbranch_scc1 L_jn_48
    s_add_u32 s0, s100, 1024
    buffer_load_dwordx4 v[134:137], v247, s[20:23], s0 offen offset:0 sc1
    buffer_load_dwordx4 v[138:141], v247, s[20:23], s0 offen offset:3072 sc1
    s_add_u32 s0, s100, 7168
    buffer_load_dwordx4 v[142:145], v247, s[20:23], s0 offen offset:0 sc1
    buffer_load_dwordx4 v[146:149], v247, s[20:23], s0 offen offset:3072 sc1
    s_add_u32 s0, s100, 13312
    buffer_load_dwordx4 v[150:153], v247, s[20:23], s0 offen offset:0 sc1
    buffer_load_dwordx4 v[154:157], v247, s[20:23], s0 offen offset:3072 sc1
    s_add_u32 s0, s100, 19456
    buffer_load_dwordx4 v[158:161], v247, s[20:23], s0 offen offset:0 sc1
    buffer_load_dwordx4 v[162:165], v247, s[20:23], s0 offen offset:3072 sc1
    s_waitcnt vmcnt(5)
    v_or3_b32 v246, v137, v141, v145
    v_add_f32 v136, v136, v140
    v_add_f32 v136, v136, v144
    v_pk_add_f32 v[134:135], v[134:135], v[138:139]
    v_pk_add_f32 v[134:135], v[134:135], v[142:143]
    s_waitcnt vmcnt(3)
    v_or3_b32 v246, v246, v149, v153
    v_pk_add_f32 v[134:135], v[134:135], v[146:147]
    v_add_f32 v136, v136, v148
    v_pk_add_f32 v[134:135], v[134:135], v[150:151]
    v_add_f32 v136, v136, v152
    s_waitcnt vmcnt(1)
    v_or3_b32 v246, v246, v157, v161
    v_pk_add_f32 v[134:135], v[134:135], v[154:155]
    v_add_f32 v136, v136, v156
    v_pk_add_f32 v[134:135], v[134:135], v[158:159]
    v_add_f32 v136, v136, v160
    s_waitcnt vmcnt(0)
    v_or_b32 v246, v246, v165
    v_cmp_ne_u32 vcc, 0, v246
    v_pk_add_f32 v[134:135], v[134:135], v[162:163]
    v_add_f32 v136, v136, v164
    s_cbranch_vccz L_gok_50
    s_mov_b32 s57, 0
L_poll_51:
    s_add_u32 s0, s100, 1024
    buffer_load_dwordx4 v[134:137], v247, s[20:23], s0 offen offset:0 sc1
    buffer_load_dwordx4 v[138:141], v247, s[20:23], s0 offen offset:3072 sc1
    s_add_u32 s0, s100, 7168
    buffer_load_dwordx4 v[142:145], v247, s[20:23], s0 offen offset:0 sc1
    buffer_load_dwordx4 v[146:149], v247, s[20:23], s0 offen offset:3072 sc1
    s_add_u32 s0, s100, 13312
    buffer_load_dwordx4 v[150:153], v247, s[20:23], s0 offen offset:0 sc1
    buffer_load_dwordx4 v[154:157], v247, s[20:23], s0 offen offset:3072 sc1
    s_add_u32 s0, s100, 19456
    buffer_load_dwordx4 v[158:161], v247, s[20:23], s0 offen offset:0 sc1
    buffer_load_dwordx4 v[162:165], v247, s[20:23], s0 offen offset:3072 sc1
    s_waitcnt vmcnt(5)
    v_or3_b32 v246, v137, v141, v145
    v_add_f32 v136, v136, v140
    v_add_f32 v136, v136, v144
    v_pk_add_f32 v[134:135], v[134:135], v[138:139]
    v_pk_add_f32 v[134:135], v[134:135], v[142:143]
    s_waitcnt vmcnt(3)
    v_or3_b32 v246, v246, v149, v153
    v_pk_add_f32 v[134:135], v[134:135], v[146:147]
    v_add_f32 v136, v136, v148
    v_pk_add_f32 v[134:135], v[134:135], v[150:151]
    v_add_f32 v136, v136, v152
    s_waitcnt vmcnt(1)
    v_or3_b32 v246, v246, v157, v161
    v_pk_add_f32 v[134:135], v[134:135], v[154:155]
    v_add_f32 v136, v136, v156
    v_pk_add_f32 v[134:135], v[134:135], v[158:159]
    v_add_f32 v136, v136, v160
    s_waitcnt vmcnt(0)
    v_or_b32 v246, v246, v165
    v_cmp_ne_u32 vcc, 0, v246
    v_pk_add_f32 v[134:135], v[134:135], v[162:163]
    v_add_f32 v136, v136, v164
    s_add_u32 s57, s57, 1
    s_cmp_gt_u32 s57, 200000
    s_cbranch_scc1 L_end
    s_cbranch_vccnz L_poll_51
L_gok_50:
    v_mul_f32 v138, 0xbb000000, v134
    v_mul_f32 v145, 0x3b000000, v136
    v_fma_f32 v145, -v138, v138, v145
    v_max_f32 v145, 0, v145
    v_add_f32 v144, 0x3727c5ac, v145
    v_rsq_f32 v144, v144
    v_fma_f32 v142, v138, s52, v135
    v_mul_f32 v142, v142, v144
    v_add_f32 v140, 1.0, v144
    v_mul_f32 v141, v138, v144
    v_max_f32_dpp v146, v142, v142 row_ror:8 row_mask:0xf bank_mask:0xf
    v_mul_f32 v246, v140, v140
    v_fmaak_f32 v246, v246, v145, 0x3727c5ac
    v_max_f32_dpp v146, v146, v146 row_ror:4 row_mask:0xf bank_mask:0xf
    v_rsq_f32 v246, v246
    v_add_u32 v248, 157696, v247
    v_max_f32_dpp v146, v146, v146 row_ror:2 row_mask:0xf bank_mask:0xf
    v_mul_f32 v139, v140, v246
    v_lshrrev_b32 v249, 2, v247
    v_max_f32_dpp v146, v146, v146 row_ror:1 row_mask:0xf bank_mask:0xf
    v_mov_b32 v147, v146
    v_add_u32 v249, 158976, v249
    ds_write_b128 v248, v[138:141]
    ds_write2_b32 v249, v138, v139 offset0:0 offset1:80
    v_permlane32_swap_b32 v146, v147
    v_lshrrev_b32 v248, 2, v0
    v_max_f32 v146, v146, v147
    v_mov_b32 v147, v146
    v_lshlrev_b32 v248, 8, v248
    v_and_b32 v249, 3, v0
    v_permlane16_swap_b32 v146, v147
    v_lshl_add_u32 v143, s5, 6, v0
    v_max_f32 v146, v146, v147
    v_cmp_eq_f32 vcc, v142, v146
    v_mov_b32 v246, 0
    s_cmp_eq_u32 s4, 0
    s_cselect_b32 s0, s101, 8388608
    s_ff1_i32_b64 s1, vcc
    s_and_b32 s1, s1, 63
    s_lshl_b64 exec, 1, s1
    buffer_store_dwordx2 v[142:143], v246, s[20:23], s0 offen offset:1280 sc1
    s_mov_b64 exec, -1
    v_lshl_add_u32 v248, v249, 2, v248
    s_lshr_b32 s0, s1, 4
    s_mul_i32 s0, s0, 1792
    s_lshl4_add_u32 s0, s1, s0
    s_add_u32 s0, s0, 149504
    v_add_u32 v248, s0, v248
    s_mov_b32 exec_hi, 0
    ds_read_b32 v249, v248
    s_mov_b64 exec, -1
    v_readlane_b32 s60, v144, s1
    v_readlane_b32 s61, v141, s1
    v_readlane_b32 s68, v142, s1
    s_mul_i32 s0, s4, 3072
    s_add_u32 s0, s0, s100
    v_lshlrev_b32 v246, 2, v0
    v_mov_b32 v247, s61
    s_mov_b32 exec_hi, 0
    s_waitcnt lgkmcnt(0)
    v_lshlrev_b32 v248, 16, v249
    v_and_b32 v249, 0xffff0000, v249
    v_fma_f32 v248, v248, s60, v247
    v_fma_f32 v249, v249, s60, v247
    v_cvt_pk_bf16_f32 v249, v248, v249
    buffer_store_dword v249, v246, s[20:23], s0 offen offset:2432 sc1
    s_mov_b64 exec, -1
L_jn_48:
    s_waitcnt lgkmcnt(0)
    s_barrier
    ds_read_b64 v[150:151], v12 offset:264
    ds_read_b64 v[152:153], v12 offset:520
    ds_read_b64 v[154:155], v12 offset:776
    ds_read_b64 v[156:157], v12 offset:1032
    s_waitcnt lgkmcnt(0)
    v_pk_fma_f32 v[54:55], v[54:55], v[150:151], v[150:151] op_sel:[0,0,1] op_sel_hi:[1,0,1]
    v_pk_fma_f32 v[56:57], v[56:57], v[150:151], v[150:151] op_sel:[0,0,1] op_sel_hi:[1,0,1]
    v_pk_fma_f32 v[58:59], v[58:59], v[152:153], v[152:153] op_sel:[0,0,1] op_sel_hi:[1,0,1]
    v_pk_fma_f32 v[60:61], v[60:61], v[152:153], v[152:153] op_sel:[0,0,1] op_sel_hi:[1,0,1]
    v_pk_fma_f32 v[62:63], v[62:63], v[154:155], v[154:155] op_sel:[0,0,1] op_sel_hi:[1,0,1]
    v_pk_fma_f32 v[64:65], v[64:65], v[154:155], v[154:155] op_sel:[0,0,1] op_sel_hi:[1,0,1]
    v_pk_fma_f32 v[66:67], v[66:67], v[156:157], v[156:157] op_sel:[0,0,1] op_sel_hi:[1,0,1]
    v_pk_fma_f32 v[68:69], v[68:69], v[156:157], v[156:157] op_sel:[0,0,1] op_sel_hi:[1,0,1]
    v_cvt_pk_bf16_f32 v102, v54, v55
    v_cvt_pk_bf16_f32 v103, v56, v57
    v_cvt_pk_bf16_f32 v104, v58, v59
    v_cvt_pk_bf16_f32 v105, v60, v61
    v_cvt_pk_bf16_f32 v106, v62, v63
    v_cvt_pk_bf16_f32 v107, v64, v65
    v_cvt_pk_bf16_f32 v108, v66, v67
    v_cvt_pk_bf16_f32 v109, v68, v69
    v_permlane16_swap_b32 v102, v104
    v_permlane16_swap_b32 v103, v105
    v_permlane16_swap_b32 v106, v108
    v_permlane16_swap_b32 v107, v109
    buffer_store_dwordx4 v[102:105], v254, s[36:39], s65 offen
    buffer_store_dwordx4 v[106:109], v254, s[36:39], s69 offen
    s_cmp_lt_i32 s7, 0
    s_cbranch_scc1 L_nw_52
    ds_read_b64_tr_b16 v[134:135], v124 offset:0
    ds_read_b64_tr_b16 v[136:137], v124 offset:256
    ds_read_b64_tr_b16 v[138:139], v125 offset:0
    ds_read_b64_tr_b16 v[140:141], v125 offset:256
    ds_read_b64_tr_b16 v[142:143], v124 offset:32768
    ds_read_b64_tr_b16 v[144:145], v124 offset:33024
    ds_read_b64_tr_b16 v[146:147], v125 offset:32768
    ds_read_b64_tr_b16 v[148:149], v125 offset:33024
    ds_read_b64_tr_b16 v[150:151], v124 offset:2048
    ds_read_b64_tr_b16 v[152:153], v124 offset:2304
    ds_read_b64_tr_b16 v[154:155], v125 offset:2048
    ds_read_b64_tr_b16 v[156:157], v125 offset:2304
    ds_read_b64_tr_b16 v[158:159], v124 offset:34816
    ds_read_b64_tr_b16 v[160:161], v124 offset:35072
    ds_read_b64_tr_b16 v[162:163], v125 offset:34816
    ds_read_b64_tr_b16 v[164:165], v125 offset:35072
    ds_read_b64_tr_b16 v[166:167], v124 offset:4096
    ds_read_b64_tr_b16 v[168:169], v124 offset:4352
    ds_read_b64_tr_b16 v[170:171], v125 offset:4096
    ds_read_b64_tr_b16 v[172:173], v125 offset:4352
    ds_read_b64_tr_b16 v[174:175], v124 offset:36864
    ds_read_b64_tr_b16 v[176:177], v124 offset:37120
    ds_read_b64_tr_b16 v[178:179], v125 offset:36864
    ds_read_b64_tr_b16 v[180:181], v125 offset:37120
    ds_read_b64_tr_b16 v[182:183], v124 offset:6144
    ds_read_b64_tr_b16 v[184:185], v124 offset:6400
    ds_read_b64_tr_b16 v[186:187], v125 offset:6144
    ds_read_b64_tr_b16 v[188:189], v125 offset:6400
    ds_read_b64_tr_b16 v[190:191], v124 offset:38912
    ds_read_b64_tr_b16 v[192:193], v124 offset:39168
    ds_read_b64_tr_b16 v[194:195], v125 offset:38912
    ds_read_b64_tr_b16 v[196:197], v125 offset:39168
    s_waitcnt vmcnt(0)
    s_barrier
    v_and_b32 v246, 31, v0
    v_mul_u32_u24 v246, 2304, v246
    v_add_u32 v246, 6094848, v246
    s_mov_b32 s57, 0
L_poll_53:
    buffer_load_dwordx2 v[248:249], v246, s[20:23], 0 offen offset:1280 sc1
    s_waitcnt vmcnt(0)
    v_cmp_eq_u32 vcc, -1, v249
    s_add_u32 s57, s57, 1
    s_cmp_gt_u32 s57, 200000
    s_cbranch_scc1 L_end
    s_cbranch_vccnz L_poll_53
    v_max_f32_dpp v247, v248, v248 row_ror:8 row_mask:0xf bank_mask:0xf
    s_nop 1
    v_max_f32_dpp v247, v247, v247 row_ror:4 row_mask:0xf bank_mask:0xf
    s_nop 1
    v_max_f32_dpp v247, v247, v247 row_ror:2 row_mask:0xf bank_mask:0xf
    s_nop 1
    v_max_f32_dpp v247, v247, v247 row_ror:1 row_mask:0xf bank_mask:0xf
    v_mov_b32 v246, v247
    s_nop 1
    v_permlane16_swap_b32 v246, v247
    v_max_f32 v247, v246, v247
    v_cmp_eq_f32 vcc, v248, v247
    s_nop 0
    s_ff1_i32_b32 s1, vcc_lo
    s_and_b32 s1, s1, 31
    v_readlane_b32 s56, v249, s1
    v_readlane_b32 s55, v248, s1
    s_lshr_b32 s0, s56, 6
    s_lshl2_add_u32 s0, s0, s3
    s_mul_i32 s0, s0, 6144
    s_add_u32 s65, s0, 5310848
    buffer_load_dwordx4 v[102:105], v129, s[20:23], s65 offen offset:0 sc1
    buffer_load_dwordx4 v[106:109], v129, s[20:23], s65 offen offset:64 sc1
    buffer_load_dwordx4 v[110:113], v129, s[20:23], s65 offen offset:3072 sc1
    buffer_load_dwordx4 v[114:117], v129, s[20:23], s65 offen offset:3136 sc1
    s_waitcnt vmcnt(0) lgkmcnt(0)
    s_mov_b32 s57, 0
L_ffb_54:
    v_mfma_f32_16x16x32_bf16 v[198:201], v[134:137], v[102:105], 0
    v_mfma_f32_16x16x32_bf16 v[202:205], v[138:141], v[102:105], 0
    v_mfma_f32_16x16x32_bf16 v[206:209], v[142:145], v[102:105], 0
    v_mfma_f32_16x16x32_bf16 v[210:213], v[146:149], v[102:105], 0
    v_mfma_f32_16x16x32_bf16 v[198:201], v[150:153], v[106:109], v[198:201]
    v_mfma_f32_16x16x32_bf16 v[202:205], v[154:157], v[106:109], v[202:205]
    v_mfma_f32_16x16x32_bf16 v[206:209], v[158:161], v[106:109], v[206:209]
    v_mfma_f32_16x16x32_bf16 v[210:213], v[162:165], v[106:109], v[210:213]
    v_mfma_f32_16x16x32_bf16 v[198:201], v[166:169], v[110:113], v[198:201]
    v_mfma_f32_16x16x32_bf16 v[202:205], v[170:173], v[110:113], v[202:205]
    v_mfma_f32_16x16x32_bf16 v[206:209], v[174:177], v[110:113], v[206:209]
    v_mfma_f32_16x16x32_bf16 v[210:213], v[178:181], v[110:113], v[210:213]
    v_mfma_f32_16x16x32_bf16 v[198:201], v[182:185], v[114:117], v[198:201]
    v_mfma_f32_16x16x32_bf16 v[202:205], v[186:189], v[114:117], v[202:205]
    v_mfma_f32_16x16x32_bf16 v[206:209], v[190:193], v[114:117], v[206:209]
    v_mfma_f32_16x16x32_bf16 v[210:213], v[194:197], v[114:117], v[210:213]
    s_mov_b32 exec_lo, 0x10001
    s_mov_b32 exec_hi, 0x10001
    s_nop 2
    ds_write_b128 v126, v[198:201] offset:0
    ds_write_b128 v126, v[202:205] offset:64
    ds_write_b128 v126, v[206:209] offset:128
    ds_write_b128 v126, v[210:213] offset:192
    s_mov_b64 exec, -1
    s_add_u32 s57, s57, 1
    s_cmp_lt_u32 s57, 2000
    s_waitcnt lgkmcnt(0)
    s_barrier
    ds_read2st64_b32 v[250:251], v127 offset0:0 offset1:1
    ds_read2st64_b32 v[252:253], v127 offset0:2 offset1:3
    s_waitcnt lgkmcnt(0)
    v_add_f32 v250, v250, v251
    v_add_f32 v252, v252, v253
    v_add_f32 v250, v250, v252
    v_mul_f32 v252, 0xbfb8aa3b, v250
    v_cmp_u_f32 vcc, v250, v250
    v_exp_f32 v252, v252
    v_mul_f32_dpp v250, v250, v250 row_ror:8 row_mask:0xf bank_mask:0xf
    v_add_f32 v252, 1.0, v252
    v_rcp_f32 v252, v252
    s_cselect_b64 vcc, vcc, 0
    v_mul_f32 v250, v250, v252
    v_cvt_pk_bf16_f32 v250, v250, v250
    s_cbranch_vccnz L_ffr_55
    s_nop 0
    v_and_b32_dpp v102, v250, v118 row_newbcast:0 row_mask:0xf bank_mask:0xf
    v_and_b32_dpp v103, v250, v119 row_newbcast:0 row_mask:0xf bank_mask:0xf
    v_and_b32_dpp v104, v250, v120 row_newbcast:0 row_mask:0xf bank_mask:0xf
    v_and_b32_dpp v105, v250, v121 row_newbcast:0 row_mask:0xf bank_mask:0xf
    v_and_b32_dpp v106, v250, v118 row_newbcast:1 row_mask:0xf bank_mask:0xf
    v_and_b32_dpp v107, v250, v119 row_newbcast:1 row_mask:0xf bank_mask:0xf
    v_and_b32_dpp v108, v250, v120 row_newbcast:1 row_mask:0xf bank_mask:0xf
    v_and_b32_dpp v109, v250, v121 row_newbcast:1 row_mask:0xf bank_mask:0xf
    v_mfma_f32_16x16x32_bf16 v[198:201], v[102:105], v[70:73], 0
    v_and_b32_dpp v110, v250, v118 row_newbcast:2 row_mask:0xf bank_mask:0xf
    v_and_b32_dpp v111, v250, v119 row_newbcast:2 row_mask:0xf bank_mask:0xf
    v_and_b32_dpp v112, v250, v120 row_newbcast:2 row_mask:0xf bank_mask:0xf
    v_and_b32_dpp v113, v250, v121 row_newbcast:2 row_mask:0xf bank_mask:0xf
    v_mfma_f32_16x16x32_bf16 v[198:201], v[106:109], v[74:77], v[198:201]
    v_and_b32_dpp v114, v250, v118 row_newbcast:3 row_mask:0xf bank_mask:0xf
    v_and_b32_dpp v115, v250, v119 row_newbcast:3 row_mask:0xf bank_mask:0xf
    v_and_b32_dpp v116, v250, v120 row_newbcast:3 row_mask:0xf bank_mask:0xf
    v_and_b32_dpp v117, v250, v121 row_newbcast:3 row_mask:0xf bank_mask:0xf
    v_mfma_f32_16x16x32_bf16 v[198:201], v[110:113], v[78:81], v[198:201]
    v_and_b32_dpp v102, v250, v118 row_newbcast:4 row_mask:0xf bank_mask:0xf
    v_and_b32_dpp v103, v250, v119 row_newbcast:4 row_mask:0xf bank_mask:0xf
    v_and_b32_dpp v104, v250, v120 row_newbcast:4 row_mask:0xf bank_mask:0xf
    v_and_b32_dpp v105, v250, v121 row_newbcast:4 row_mask:0xf bank_mask:0xf
    v_mfma_f32_16x16x32_bf16 v[198:201], v[114:117], v[82:85], v[198:201]
    v_and_b32_dpp v106, v250, v118 row_newbcast:5 row_mask:0xf bank_mask:0xf
    v_and_b32_dpp v107, v250, v119 row_newbcast:5 row_mask:0xf bank_mask:0xf
    v_and_b32_dpp v108, v250, v120 row_newbcast:5 row_mask:0xf bank_mask:0xf
    v_and_b32_dpp v109, v250, v121 row_newbcast:5 row_mask:0xf bank_mask:0xf
    v_mfma_f32_16x16x32_bf16 v[198:201], v[102:105], v[86:89], v[198:201]
    v_and_b32_dpp v110, v250, v118 row_newbcast:6 row_mask:0xf bank_mask:0xf
    v_and_b32_dpp v111, v250, v119 row_newbcast:6 row_mask:0xf bank_mask:0xf
    v_and_b32_dpp v112, v250, v120 row_newbcast:6 row_mask:0xf bank_mask:0xf
    v_and_b32_dpp v113, v250, v121 row_newbcast:6 row_mask:0xf bank_mask:0xf
    v_mfma_f32_16x16x32_bf16 v[198:201], v[106:109], v[90:93], v[198:201]
    v_and_b32_dpp v114, v250, v118 row_newbcast:7 row_mask:0xf bank_mask:0xf
    v_and_b32_dpp v115, v250, v119 row_newbcast:7 row_mask:0xf bank_mask:0xf
    v_and_b32_dpp v116, v250, v120 row_newbcast:7 row_mask:0xf bank_mask:0xf
    v_and_b32_dpp v117, v250, v121 row_newbcast:7 row_mask:0xf bank_mask:0xf
    v_mfma_f32_16x16x32_bf16 v[198:201], v[110:113], v[94:97], v[198:201]
    s_nop 0
    v_mfma_f32_16x16x32_bf16 v[198:201], v[114:117], v[98:101], v[198:201]
    s_nop 7
    v_cvt_pk_bf16_f32 v250, v198, v199
    v_cvt_pk_bf16_f32 v251, v200, v201
    s_mov_b32 exec_hi, 0
    buffer_store_dwordx2 v[250:251], v128, s[20:23], s66 offen sc1
    s_mov_b64 exec, -1
L_ffn_done1:
    s_lshr_b32 s0, s56, 6
    s_cmp_eq_u32 s0, s5
    s_cbranch_scc0 L_done
    s_cmp_eq_u32 s3, 0
    s_cbranch_scc0 L_done
    s_and_b32 s1, s56, 63
    s_lshr_b32 s60, s1, 4
    s_add_u32 s60, s60, 1
    s_and_b32 s61, s1, 15
    s_lshl_b32 s1, s1, 11
    s_add_u32 s64, s64, s1
    s_mov_b32 s62, s4
    s_lshl_b32 s0, s60, 11
    s_add_u32 s69, s0, 147456
    v_and_b32 v247, 7, v1
    v_lshrrev_b32 v246, 3, v0
    v_lshlrev_b32 v246, 10, v246
    v_lshl_add_u32 v246, v247, 4, v246
    v_mov_b32 v218, 0
    v_mov_b32 v219, 0
    v_mov_b32 v220, 0
    v_mov_b32 v221, 0
    s_lshl_b32 s1, s61, 4
    s_add_u32 s0, s69, s1
    v_and_b32 v248, 1, v2
    v_lshlrev_b32 v248, 3, v248
    v_lshl_add_u32 v249, v247, 8, v248
    v_add_u32 v249, s0, v249
    ds_read_b64 v[196:197], v249
    s_lshl_b32 s0, s60, 8
    s_add_u32 s0, s0, s1
    s_add_u32 s0, s0, 157704
    v_mov_b32 v249, s0
    ds_read_b64 v[184:185], v249
    v_lshl_add_u32 v248, v247, 4, v248
    v_mov_b32 v249, 0x3f80
    v_mov_b32 v186, 0x3f800000
    v_cndmask_b32 v249, v249, v186, s[46:47]
    v_lshrrev_b32 v247, 1, v247
    v_cmp_eq_u32 vcc, 0, v247
    s_nop 1
    v_cndmask_b32 v186, 0, v249, vcc
    v_cmp_eq_u32 vcc, 1, v247
    s_nop 1
    v_cndmask_b32 v187, 0, v249, vcc
    v_cmp_eq_u32 vcc, 2, v247
    s_nop 1
    v_cndmask_b32 v188, 0, v249, vcc
    v_cmp_eq_u32 vcc, 3, v247
    s_nop 1
    v_cndmask_b32 v189, 0, v249, vcc
    v_mov_b32 v247, s55
    v_mul_f32 v247, 0xbfb8aa3b, v247
    v_exp_f32 v247, v247
    s_waitcnt lgkmcnt(0)
    v_lshlrev_b32 v194, 16, v196
    v_add_f32 v247, 1.0, v247
    v_rcp_f32 v247, v247
    v_and_b32 v195, 0xffff0000, v196
    v_lshlrev_b32 v196, 16, v197
    v_and_b32 v197, 0xffff0000, v197
    v_fma_f32 v194, v194, v184, v185
    v_fma_f32 v195, v195, v184, v185
    v_fma_f32 v196, v196, v184, v185
    v_fma_f32 v197, v197, v184, v185
    s_mov_b32 s57, 0
L_yp_56:
    s_lshl_b32 s0, s62, 7
    s_add_u32 s0, s0, 6275072
    buffer_load_dwordx4 v[198:201], v246, s[20:23], s0 offen sc1
    s_add_u32 s0, s0, 8192
    buffer_load_dwordx4 v[202:205], v246, s[20:23], s0 offen sc1
    s_add_u32 s0, s0, 8192
    buffer_load_dwordx4 v[206:209], v246, s[20:23], s0 offen sc1
    s_add_u32 s0, s0, 8192
    buffer_load_dwordx4 v[210:213], v246, s[20:23], s0 offen sc1
    s_add_u32 s0, s0, 8192
    buffer_load_dwordx4 v[214:217], v246, s[20:23], s0 offen sc1
    s_add_u32 s0, s0, 8192
    s_mov_b64 exec, 0xffffff
    buffer_load_dwordx4 v[218:221], v246, s[20:23], s0 offen sc1
    s_mov_b64 exec, -1
L_yq_57:
    s_add_u32 s57, s57, 1
    s_cmp_lt_u32 s57, 25000
    s_waitcnt vmcnt(5)
    v_mfma_f32_16x16x32_bf16 v[190:193], v[186:189], v[198:201], 0
    s_waitcnt vmcnt(4)
    v_mfma_f32_16x16x32_bf16 v[190:193], v[186:189], v[202:205], v[190:193]
    s_waitcnt vmcnt(3)
    v_mfma_f32_16x16x32_bf16 v[190:193], v[186:189], v[206:209], v[190:193]
    s_waitcnt vmcnt(2)
    v_mfma_f32_16x16x32_bf16 v[190:193], v[186:189], v[210:213], v[190:193]
    s_waitcnt vmcnt(1)
    v_mfma_f32_16x16x32_bf16 v[190:193], v[186:189], v[214:217], v[190:193]
    s_waitcnt vmcnt(0)
    v_mfma_f32_16x16x32_bf16 v[190:193], v[186:189], v[218:221], v[190:193]
    s_nop 7
    v_cmp_u_f32 vcc, v190, v190
    s_nop 0
    s_cselect_b64 vcc, vcc, 0
    s_cbranch_vccnz L_yp_56
    v_add_f32_dpp v190, v190, v190 row_ror:8 row_mask:0xf bank_mask:0xf
    v_add_f32_dpp v191, v191, v191 row_ror:8 row_mask:0xf bank_mask:0xf
    v_add_f32_dpp v192, v192, v192 row_ror:8 row_mask:0xf bank_mask:0xf
    v_add_f32_dpp v193, v193, v193 row_ror:8 row_mask:0xf bank_mask:0xf
    v_fmac_f32 v194, v190, v247
    v_fmac_f32 v195, v191, v247
    v_fmac_f32 v196, v192, v247
    v_fmac_f32 v197, v193, v247
    v_cvt_pk_bf16_f32 v194, v194, v195
    v_cvt_pk_bf16_f32 v195, v196, v197
    s_mov_b64 exec, 0xff00ff
    buffer_store_dwordx2 v[194:195], v248, s[36:39], s64 offen
    s_mov_b64 exec, -1
L_done:
L_end:
    s_endpgm
L_nw_52:
    s_waitcnt vmcnt(0)
    s_barrier
    s_cmp_eq_u32 s3, 0
    s_cbranch_scc0 L_done
    v_and_b32 v246, 31, v0
    v_mul_u32_u24 v246, 2304, v246
    v_add_u32 v246, 6094848, v246
    s_mov_b32 s57, 0
L_poll_59:
    buffer_load_dwordx2 v[248:249], v246, s[20:23], 0 offen offset:1280 sc1
    s_waitcnt vmcnt(0)
    v_cmp_lt_f32 vcc, s68, v248
    s_cbranch_vccnz L_lost_58
    v_cmp_eq_u32 vcc, -1, v249
    s_add_u32 s57, s57, 1
    s_cmp_gt_u32 s57, 200000
    s_cbranch_scc1 L_end
    s_cbranch_vccnz L_poll_59
    v_max_f32_dpp v247, v248, v248 row_ror:8 row_mask:0xf bank_mask:0xf
    s_nop 1
    v_max_f32_dpp v247, v247, v247 row_ror:4 row_mask:0xf bank_mask:0xf
    s_nop 1
    v_max_f32_dpp v247, v247, v247 row_ror:2 row_mask:0xf bank_mask:0xf
    s_nop 1
    v_max_f32_dpp v247, v247, v247 row_ror:1 row_mask:0xf bank_mask:0xf
    v_mov_b32 v246, v247
    s_nop 1
    v_permlane16_swap_b32 v246, v247
    v_max_f32 v247, v246, v247
    v_cmp_eq_f32 vcc, v248, v247
    s_nop 0
    s_ff1_i32_b32 s1, vcc_lo
    s_and_b32 s1, s1, 31
    v_readlane_b32 s56, v249, s1
    v_readlane_b32 s55, v248, s1
    s_nop 3
    s_branch L_ffn_done1
L_lost_58:
    s_branch L_done
L_nog_14:
    s_barrier
    s_add_u32 m0, s58, 18432
    s_mov_b32 s59, 2699264
    buffer_load_dwordx4 v6, s[20:23], s59 offen offset:0 sc1 lds
    buffer_load_dwordx4 v7, s[20:23], s59 offen offset:1024 sc1 lds
    buffer_load_dwordx4 v8, s[20:23], s59 offen offset:2048 sc1 lds
    s_mov_b32 exec_hi, 0
    buffer_load_dwordx4 v9, s[20:23], s59 offen offset:3072 sc1 lds
    s_mov_b32 exec_hi, -1
    s_add_u32 m0, s58, 34816
    s_mov_b32 s59, 2715648
    buffer_load_dwordx4 v6, s[20:23], s59 offen offset:0 sc1 lds
    buffer_load_dwordx4 v7, s[20:23], s59 offen offset:1024 sc1 lds
    buffer_load_dwordx4 v8, s[20:23], s59 offen offset:2048 sc1 lds
    s_mov_b32 exec_hi, 0
    buffer_load_dwordx4 v9, s[20:23], s59 offen offset:3072 sc1 lds
    s_mov_b32 exec_hi, -1
    s_cmp_eq_u32 s3, 1
    s_cbranch_scc0 L_w23_60
    s_mov_b32 s57, 0
L_poll_61:
    s_add_u32 s0, s100, 0
    buffer_load_dwordx4 v[134:137], v247, s[20:23], s0 offen offset:0 sc1
    buffer_load_dwordx4 v[138:141], v247, s[20:23], s0 offen offset:3072 sc1
    s_add_u32 s0, s100, 6144
    buffer_load_dwordx4 v[142:145], v247, s[20:23], s0 offen offset:0 sc1
    buffer_load_dwordx4 v[146:149], v247, s[20:23], s0 offen offset:3072 sc1
    s_add_u32 s0, s100, 12288
    buffer_load_dwordx4 v[150:153], v247, s[20:23], s0 offen offset:0 sc1
    buffer_load_dwordx4 v[154:157], v247, s[20:23], s0 offen offset:3072 sc1
    s_add_u32 s0, s100, 18432
    buffer_load_dwordx4 v[158:161], v247, s[20:23], s0 offen offset:0 sc1
    buffer_load_dwordx4 v[162:165], v247, s[20:23], s0 offen offset:3072 sc1
    s_waitcnt vmcnt(5)
    v_or3_b32 v246, v137, v141, v145
    v_add_f32 v136, v136, v140
    v_add_f32 v136, v136, v144
    v_pk_add_f32 v[134:135], v[134:135], v[138:139]
    v_pk_add_f32 v[134:135], v[134:135], v[142:143]
    s_waitcnt vmcnt(3)
    v_or3_b32 v246, v246, v149, v153
    v_pk_add_f32 v[134:135], v[134:135], v[146:147]
    v_add_f32 v136, v136, v148
    v_pk_add_f32 v[134:135], v[134:135], v[150:151]
    v_add_f32 v136, v136, v152
    s_waitcnt vmcnt(1)
    v_or3_b32 v246, v246, v157, v161
    v_pk_add_f32 v[134:135], v[134:135], v[154:155]
    v_add_f32 v136, v136, v156
    v_pk_add_f32 v[134:135], v[134:135], v[158:159]
    v_add_f32 v136, v136, v160
    s_waitcnt vmcnt(0)
    v_or_b32 v246, v246, v165
    v_cmp_ne_u32 vcc, 0, v246
    v_pk_add_f32 v[134:135], v[134:135], v[162:163]
    v_add_f32 v136, v136, v164
    s_add_u32 s57, s57, 1
    s_cmp_gt_u32 s57, 200000
    s_cbranch_scc1 L_end
    s_cbranch_vccnz L_poll_61
    v_mul_f32 v138, 0xbb000000, v134
    v_mul_f32 v145, 0x3b000000, v136
    v_fma_f32 v145, -v138, v138, v145
    v_max_f32 v145, 0, v145
    v_add_f32 v144, 0x3727c5ac, v145
    v_rsq_f32 v144, v144
    s_nop 0
    v_add_f32 v140, 1.0, v144
    v_mul_f32 v141, v138, v144
    v_mul_f32 v246, v140, v140
    v_fmaak_f32 v246, v246, v145, 0x3727c5ac
    v_rsq_f32 v246, v246
    v_add_u32 v248, 157696, v247
    v_mul_f32 v139, v140, v246
    v_lshrrev_b32 v249, 2, v247
    v_add_u32 v249, 158976, v249
    ds_write_b128 v248, v[138:141]
    ds_write2_b32 v249, v138, v139 offset0:0 offset1:80
L_w23_60:
    s_mov_b32 s0, 8388608
    buffer_store_dword v246, v3, s[20:23], s0 offen
    s_waitcnt vmcnt(5) lgkmcnt(0)
    s_branch L_jn_15
L_rgs_20:
    s_cmp_lt_i32 s7, 0
    s_cselect_b32 s54, 0, 1
    s_cbranch_scc1 L_rgb_21
    s_mov_b32 s57, 0
L_poll_62:
    buffer_load_dwordx2 v[248:249], v246, s[20:23], 0 offen offset:1024 sc1
    s_waitcnt vmcnt(0)
    v_cmp_eq_u32 vcc, -1, v249
    s_add_u32 s57, s57, 1
    s_cmp_gt_u32 s57, 200000
    s_cbranch_scc1 L_end
    s_cbranch_vccnz L_poll_62
    s_branch L_rgb_21
L_unk_27:
    v_and_b32 v246, 31, v0
    v_mul_u32_u24 v246, 2304, v246
    v_add_u32 v246, 6094848, v246
    s_mov_b32 s57, 0
L_poll_63:
    buffer_load_dwordx2 v[248:249], v246, s[20:23], 0 offen offset:1024 sc1
    s_waitcnt vmcnt(0)
    v_cmp_eq_u32 vcc, -1, v249
    s_add_u32 s57, s57, 1
    s_cmp_gt_u32 s57, 200000
    s_cbranch_scc1 L_end
    s_cbranch_vccnz L_poll_63
    v_max_f32_dpp v247, v248, v248 row_ror:8 row_mask:0xf bank_mask:0xf
    s_nop 1
    v_max_f32_dpp v247, v247, v247 row_ror:4 row_mask:0xf bank_mask:0xf
    s_nop 1
    v_max_f32_dpp v247, v247, v247 row_ror:2 row_mask:0xf bank_mask:0xf
    s_nop 1
    v_max_f32_dpp v247, v247, v247 row_ror:1 row_mask:0xf bank_mask:0xf
    v_mov_b32 v246, v247
    s_nop 1
    v_permlane16_swap_b32 v246, v247
    v_max_f32 v247, v246, v247
    v_cmp_eq_f32 vcc, v248, v247
    s_nop 0
    s_ff1_i32_b32 s1, vcc_lo
    s_and_b32 s1, s1, 31
    v_readlane_b32 s56, v249, s1
    v_readlane_b32 s55, v248, s1
    s_nop 3
    s_branch L_known_26
L_plain0:
    ds_read_b128 v[134:137], v5 offset:0
    ds_read_b128 v[138:141], v5 offset:1024
    ds_read_b128 v[142:145], v3 offset:2048
    ds_read_b128 v[146:149], v3 offset:3072
    ds_read_b128 v[150:153], v3 offset:4096
    s_waitcnt lgkmcnt(4)
    v_mfma_f32_16x16x32_bf16 v[190:193], a[4:7], v[134:137], 0
    ds_read_b128 v[154:157], v3 offset:5120
    v_fma_f32 v234, v28, v182, v234
    v_mfma_f32_16x16x32_bf16 v[194:197], v[134:137], a[8:11], 0
    v_fma_f32 v238, v32, v182, v238
    s_waitcnt lgkmcnt(4)
    v_mfma_f32_16x16x32_bf16 v[190:193], a[16:19], v[138:141], v[190:193]
    ds_read_b128 v[134:137], v3 offset:6144
    v_fma_f32 v242, v36, v158, v242
    v_mfma_f32_16x16x32_bf16 v[194:197], v[138:141], a[20:23], v[194:197]
    v_mul_f32 v238, v238, v183
    s_waitcnt lgkmcnt(4)
    v_mfma_f32_16x16x32_bf16 v[190:193], a[28:31], v[142:145], v[190:193]
    ds_read_b128 v[138:141], v3 offset:7168
    v_mul_f32 v242, v242, v162
    v_mfma_f32_16x16x32_bf16 v[194:197], v[142:145], a[32:35], v[194:197]
    v_fma_f32 v235, v29, v182, v235
    s_waitcnt lgkmcnt(4)
    v_mfma_f32_16x16x32_bf16 v[190:193], a[40:43], v[146:149], v[190:193]
    ds_read_b128 v[142:145], v3 offset:8192
    v_fma_f32 v239, v33, v182, v239
    v_mfma_f32_16x16x32_bf16 v[194:197], v[146:149], a[44:47], v[194:197]
    v_fma_f32 v243, v36, v159, v243
    s_waitcnt lgkmcnt(4)
    v_mfma_f32_16x16x32_bf16 v[190:193], a[52:55], v[150:153], v[190:193]
    ds_read_b128 v[146:149], v3 offset:9216
    v_mul_f32 v239, v239, v183
    v_mfma_f32_16x16x32_bf16 v[194:197], v[150:153], a[56:59], v[194:197]
    v_mul_f32 v243, v243, v163
    s_waitcnt lgkmcnt(4)
    v_mfma_f32_16x16x32_bf16 v[190:193], a[64:67], v[154:157], v[190:193]
    ds_read_b128 v[150:153], v3 offset:10240
    v_fma_f32 v236, v30, v182, v236
    v_mfma_f32_16x16x32_bf16 v[194:197], v[154:157], a[68:71], v[194:197]
    v_fma_f32 v240, v34, v182, v240
    s_waitcnt lgkmcnt(4)
    v_mfma_f32_16x16x32_bf16 v[190:193], a[76:79], v[134:137], v[190:193]
    ds_read_b128 v[154:157], v3 offset:11264
    v_fma_f32 v244, v36, v160, v244
    v_mfma_f32_16x16x32_bf16 v[194:197], v[134:137], a[80:83], v[194:197]
    v_mul_f32 v240, v240, v183
    s_waitcnt lgkmcnt(4)
    v_mfma_f32_16x16x32_bf16 v[190:193], a[88:91], v[138:141], v[190:193]
    ds_read_b128 v[134:137], v3 offset:12288
    v_mul_f32 v244, v244, v164
    v_mfma_f32_16x16x32_bf16 v[194:197], v[138:141], a[92:95], v[194:197]
    v_fma_f32 v237, v31, v182, v237
    s_waitcnt lgkmcnt(4)
    v_mfma_f32_16x16x32_bf16 v[190:193], a[100:103], v[142:145], v[190:193]
    ds_read_b128 v[138:141], v3 offset:13312
    v_fma_f32 v241, v35, v182, v241
    v_mfma_f32_16x16x32_bf16 v[194:197], v[142:145], a[104:107], v[194:197]
    v_fma_f32 v245, v36, v161, v245
    s_waitcnt lgkmcnt(4)
    v_mfma_f32_16x16x32_bf16 v[190:193], a[112:115], v[146:149], v[190:193]
    ds_read_b128 v[142:145], v3 offset:14336
    v_mul_f32 v241, v241, v183
    v_mfma_f32_16x16x32_bf16 v[194:197], v[146:149], a[116:119], v[194:197]
    v_mul_f32 v245, v245, v165
    s_waitcnt lgkmcnt(4)
    v_mfma_f32_16x16x32_bf16 v[190:193], a[124:127], v[150:153], v[190:193]
    ds_read_b128 v[146:149], v3 offset:15360
    v_cvt_pk_bf16_f32 v110, v234, v235
    v_mfma_f32_16x16x32_bf16 v[194:197], v[150:153], a[128:131], v[194:197]
    v_cvt_pk_bf16_f32 v111, v236, v237
    s_waitcnt lgkmcnt(4)
    v_mfma_f32_16x16x32_bf16 v[190:193], a[136:139], v[154:157], v[190:193]
    v_cvt_pk_bf16_f32 v120, v238, v239
    v_cvt_pk_bf16_f32 v121, v240, v241
    v_mfma_f32_16x16x32_bf16 v[194:197], v[154:157], a[140:143], v[194:197]
    v_cvt_pk_bf16_f32 v132, v242, v243
    s_waitcnt lgkmcnt(3)
    v_mfma_f32_16x16x32_bf16 v[190:193], a[148:151], v[134:137], v[190:193]
    v_cvt_pk_bf16_f32 v133, v244, v245
    v_mul_f32 v183, 0x3eb8aa3b, v183
    v_mfma_f32_16x16x32_bf16 v[194:197], v[134:137], a[152:155], v[194:197]
    s_waitcnt lgkmcnt(2)
    v_mfma_f32_16x16x32_bf16 v[190:193], a[160:163], v[138:141], v[190:193]
    v_mfma_f32_16x16x32_bf16 v[194:197], v[138:141], a[164:167], v[194:197]
    s_waitcnt lgkmcnt(1)
    v_mfma_f32_16x16x32_bf16 v[190:193], a[172:175], v[142:145], v[190:193]
    v_mfma_f32_16x16x32_bf16 v[194:197], v[142:145], a[176:179], v[194:197]
    s_waitcnt lgkmcnt(0)
    v_mfma_f32_16x16x32_bf16 v[190:193], a[184:187], v[146:149], v[190:193]
    v_mfma_f32_16x16x32_bf16 v[194:197], v[146:149], a[188:191], v[194:197]
    s_waitcnt lgkmcnt(0)
    s_nop 5
    v_pk_fma_f32 v[190:191], v[32:33], v[174:175], v[190:191] op_sel_hi:[1,0,1]
    v_pk_fma_f32 v[194:195], v[36:37], v[166:167], v[194:195] op_sel_hi:[0,1,1]
    v_pk_fma_f32 v[192:193], v[34:35], v[174:175], v[192:193] op_sel_hi:[1,0,1]
    v_pk_fma_f32 v[196:197], v[36:37], v[168:169], v[196:197] op_sel_hi:[0,1,1]
    v_pk_mul_f32 v[190:191], v[190:191], v[174:175] op_sel:[0,1] op_sel_hi:[1,1]
    v_pk_mul_f32 v[194:195], v[194:195], v[170:171]
    v_pk_mul_f32 v[192:193], v[192:193], v[174:175] op_sel:[0,1] op_sel_hi:[1,1]
    v_pk_mul_f32 v[196:197], v[196:197], v[172:173]
    v_cvt_pk_bf16_f32 v112, v190, v191
    v_cvt_pk_bf16_f32 v113, v192, v193
    v_cvt_pk_bf16_f32 v124, v194, v195
    v_cvt_pk_bf16_f32 v125, v196, v197
    s_nop 0
    s_branch L_attn1
L_gow_2:
    s_mov_b32 s57, 0
L_poll_64:
    v_lshlrev_b32 v247, 2, v0
    global_load_dword v16, v247, s[40:41] sc1
    s_waitcnt vmcnt(0)
    v_cmp_eq_u32 vcc, 0, v16
    s_nop 0
    s_andn2_b64 vcc, vcc, s[46:47]
    s_add_u32 s57, s57, 1
    s_cmp_gt_u32 s57, 200000
    s_cbranch_scc1 L_end
    s_cbranch_vccnz L_poll_64
    s_branch L_gob_3
L_fs_5:
    s_mov_b32 s0, 81920
    buffer_store_dwordx4 v[102:105], v10, s[20:23], s0 offen sc1
    s_mov_b32 s0, 114688
    buffer_store_dwordx4 v[106:109], v10, s[20:23], s0 offen sc1
    s_mov_b32 exec_lo, 0xffff
    s_mov_b32 exec_hi, 0xffff
    s_mov_b32 s0, 65536
    buffer_store_dwordx4 v[110:113], v10, s[20:23], s0 offen sc1
    s_mov_b64 exec, -1
    s_waitcnt vmcnt(0)
    s_mov_b64 exec, s[70:71]
    buffer_store_dword v246, v15, s[20:23], 0 offen offset:256 sc1
    s_mov_b64 exec, -1
    s_mov_b32 s57, 0
L_poll_65:
    buffer_load_dword v247, v15, s[20:23], 0 offen sc1
    buffer_load_dword v248, v15, s[20:23], 0 offen offset:256 sc1
    s_waitcnt vmcnt(0)
    v_cmp_ne_u32 vcc, s53, v247
    s_nop 0
    s_cbranch_vccz L_fd_6
    s_sleep 8
    v_cmp_eq_u32 vcc, -1, v248
    s_add_u32 s57, s57, 1
    s_cmp_gt_u32 s57, 200000
    s_cbranch_scc1 L_end
    s_cbranch_vccnz L_poll_65
    v_cmp_ne_u32 vcc, s53, v248
    s_nop 0
    s_cbranch_vccz L_fd_6
    s_mov_b32 s6, 1
    s_branch L_fd_6
L_slow_7:
    s_mov_b32 s0, 2703360
    buffer_store_dwordx4 v[102:105], v10, s[20:23], s0 offen sc1
    s_mov_b32 s0, 2736128
    buffer_store_dwordx4 v[106:109], v10, s[20:23], s0 offen sc1
    s_mov_b32 exec_lo, 0xffff
    s_mov_b32 exec_hi, 0xffff
    s_mov_b32 s0, 2686976
    buffer_store_dwordx4 v[110:113], v10, s[20:23], s0 offen sc1
    s_mov_b64 exec, -1
    s_branch L_back_8
L_slow_9:
    s_mov_b64 exec, s[44:45]
    buffer_store_dwordx4 v[142:145], v14, s[20:23], 0 offen offset:256 sc1
    s_mov_b64 exec, -1
    s_branch L_back_10
L_slow_12:
    s_mov_b64 exec, s[44:45]
    buffer_store_dwordx4 v[150:153], v246, s[20:23], 0 offen sc1
    s_mov_b64 exec, -1
    s_branch L_back_13
L_ffr_25:
    s_barrier
    buffer_load_dwordx4 v[102:105], v129, s[20:23], s65 offen offset:0 sc1
    buffer_load_dwordx4 v[106:109], v129, s[20:23], s65 offen offset:64 sc1
    buffer_load_dwordx4 v[110:113], v129, s[20:23], s65 offen offset:3072 sc1
    buffer_load_dwordx4 v[114:117], v129, s[20:23], s65 offen offset:3136 sc1
    ds_read_b64_tr_b16 v[150:151], v124 offset:0
    ds_read_b64_tr_b16 v[152:153], v124 offset:256
    ds_read_b64_tr_b16 v[154:155], v125 offset:0
    ds_read_b64_tr_b16 v[156:157], v125 offset:256
    ds_read_b64_tr_b16 v[158:159], v124 offset:32768
    ds_read_b64_tr_b16 v[160:161], v124 offset:33024
    ds_read_b64_tr_b16 v[162:163], v125 offset:32768
    ds_read_b64_tr_b16 v[164:165], v125 offset:33024
    ds_read_b64_tr_b16 v[166:167], v124 offset:2048
    ds_read_b64_tr_b16 v[168:169], v124 offset:2304
    ds_read_b64_tr_b16 v[170:171], v125 offset:2048
    ds_read_b64_tr_b16 v[172:173], v125 offset:2304
    ds_read_b64_tr_b16 v[174:175], v124 offset:34816
    ds_read_b64_tr_b16 v[176:177], v124 offset:35072
    ds_read_b64_tr_b16 v[178:179], v125 offset:34816
    ds_read_b64_tr_b16 v[180:181], v125 offset:35072
    s_waitcnt vmcnt(0) lgkmcnt(0)
    s_branch L_ffb_24
L_slow_32:
    s_mov_b64 exec, 0xff00ff
    buffer_store_dwordx2 v[194:195], v248, s[20:23], s0 offen offset:2560 sc1
    s_mov_b64 exec, -1
    s_branch L_back_33
L_slow_40:
    s_mov_b32 s0, 81920
    buffer_store_dwordx4 v[102:105], v10, s[20:23], s0 offen sc1
    s_mov_b32 s0, 114688
    buffer_store_dwordx4 v[106:109], v10, s[20:23], s0 offen sc1
    s_nop 0
    s_branch L_back_41
L_slow_42:
    s_mov_b64 exec, s[70:71]
    buffer_store_dword v246, v15, s[20:23], 0 offen offset:768 sc1
    s_mov_b64 exec, -1
    s_branch L_back_43
L_slow_45:
    s_mov_b64 exec, s[44:45]
    buffer_store_dwordx4 v[142:145], v14, s[20:23], 0 offen offset:1280 sc1
    s_mov_b64 exec, -1
    s_branch L_back_46
L_ffr_55:
    s_barrier
    buffer_load_dwordx4 v[102:105], v129, s[20:23], s65 offen offset:0 sc1
    buffer_load_dwordx4 v[106:109], v129, s[20:23], s65 offen offset:64 sc1
    buffer_load_dwordx4 v[110:113], v129, s[20:23], s65 offen offset:3072 sc1
    buffer_load_dwordx4 v[114:117], v129, s[20:23], s65 offen offset:3136 sc1
    s_waitcnt vmcnt(0) lgkmcnt(0)
    s_branch L_ffb_54
L_code_end:
.fill (33280 - (L_code_end - interleave_layers__sliding_local_dilated__moe_arch_mod__prompt_kernel)) / 4, 4, 0xbf810000
.section .rodata,"a"
.p2align 6
.amdhsa_kernel interleave_layers__sliding_local_dilated__moe_arch_mod__prompt_kernel
  .amdhsa_next_free_vgpr 512
  .amdhsa_next_free_sgpr 102
  .amdhsa_accum_offset 256
  .amdhsa_group_segment_fixed_size 0
  .amdhsa_kernarg_size 88
  .amdhsa_user_sgpr_count 2
  .amdhsa_user_sgpr_kernarg_segment_ptr 1
  .amdhsa_system_sgpr_workgroup_id_x 1
.end_amdhsa_kernel
```
